```python
import torch

def _softmax(x, axis=-1):
    return torch.softmax(x, dim=axis)
def _gelu(x):
    return torch.nn.functional.gelu(x, approximate="tanh")
def _silu(x):
    return torch.nn.functional.silu(x)
def _sigmoid(x):
    return torch.sigmoid(x)
def _layernorm(x, axis=-1, eps=1e-5):
    m = x.mean(dim=axis, keepdim=True)
    v = x.var(dim=axis, keepdim=True, unbiased=False)
    return (x - m) / torch.sqrt(v + eps)
def _scatter_add(tgt, idx, src, axis=0):
    return tgt.clone().index_add_(axis, idx, src)
def _segment_sum(src, seg, n):
    out = torch.zeros((n,) + src.shape[1:], dtype=src.dtype)
    return out.index_add_(0, seg, src)
def _pad(x, pw):
    flat = tuple(v for pair in reversed(pw) for v in pair)
    return torch.nn.functional.pad(x, flat)

kernel_name = 'gated_mix__ssm_conv_h3__swiglu_ffn__prompt'

def setup_inputs():

    _w = (lambda a: (lambda t: t.to(torch.bfloat16) if t.is_floating_point() else t)(torch.as_tensor(a)))
    def _A_setup():
        B, S, D = 1, 2048, 448
        ks = 4
        return {
            "q": _w((lambda *s: torch.randn(*s, dtype=torch.bfloat16) * 0.05)(B, S, D)),
            "k": _w((lambda *s: torch.randn(*s, dtype=torch.bfloat16) * 0.2)(B, S, D)),
            "v": _w((lambda *s: torch.randn(*s, dtype=torch.bfloat16) * 0.2)(B, S, D)),
            "shift_k": _w((lambda *s: torch.randn(*s, dtype=torch.bfloat16) * 0.2)(D, ks) * 0.5),
            "ssm_k": _w((lambda *s: torch.randn(*s, dtype=torch.bfloat16) * 0.8)(D, S) * (1.0 / S ** 0.5)),
            "ssm_D": _w((lambda *s: torch.randn(*s, dtype=torch.bfloat16) * 0.2)(D)),
        }
    _A_in = _A_setup()

    def _B_setup():
        B, S, D, F = 1, 2048, 448, 1792
        return {
            "x": _w((lambda *s: torch.randn(*s, dtype=torch.bfloat16) * 0.05)(B, S, D)),
            "w_gate": _w((lambda *s: torch.randn(*s, dtype=torch.bfloat16) * 0.05)(D, F)),
            "w_up": _w((lambda *s: torch.randn(*s, dtype=torch.bfloat16) * 0.05)(D, F)),
            "w_down": _w((lambda *s: torch.randn(*s, dtype=torch.bfloat16) * 0.05)(F, D)),
        }
    _B_in = _B_setup()

    return {
        "A_q": _A_in["q"],
        "A_k": _A_in["k"],
        "A_v": _A_in["v"],
        "A_shift_k": _A_in["shift_k"],
        "A_ssm_k": _A_in["ssm_k"],
        "A_ssm_D": _A_in["ssm_D"],
        "B_x": _B_in["x"],
        "B_w_gate": _B_in["w_gate"],
        "B_w_up": _B_in["w_up"],
        "B_w_down": _B_in["w_down"],
        "gate_w": _w((lambda *s: torch.randn(*s, dtype=torch.bfloat16) * 0.05)(448) * 16.0),
    }

def reference(A_q, A_k, A_v, A_shift_k, A_ssm_k, A_ssm_D, B_x, B_w_gate, B_w_up, B_w_down, gate_w):
    def _A_ref(q, k, v, shift_k, ssm_k, ssm_D):
        B, S, D = q.shape
        ks = shift_k.shape[-1]
        k_pad = _pad(k, ((0, 0), (ks - 1, 0), (0, 0)))
        k_shift = torch.zeros_like(k)
        for t in range(ks):
            k_shift = k_shift + k_pad[:, t:t + S, :] * shift_k[:, ks - 1 - t][None, None, :]
        kv = k_shift * v
        L = 2 * S
        kv_pad = _pad(kv, ((0, 0), (0, S), (0, 0)))
        kf_pad = _pad(ssm_k, ((0, 0), (0, S)))
        kv_f = (lambda x, axes=(-2,-1): torch.fft.rfft2(x.float(), dim=axes))(kv_pad[:, None, :, :], axes=(1, 2))
        kf_f = (lambda x, axes=(-2,-1): torch.fft.rfft2(x.float(), dim=axes))(kf_pad[:, None, :], axes=(1, 2))
        kf_f = (lambda x, *d: x.permute(*d))(kf_f, 1, 2, 0)
        y_f = kv_f * kf_f[None, :, :, :]
        y = (lambda x, s, axes=(-2,-1): torch.fft.irfft2(x, s=s, dim=axes).to(torch.bfloat16))(y_f, (1, L), axes=(1, 2))[:, 0, :S, :]
        y = y + kv * ssm_D[None, None, :]
        return q * y

    def _B_ref(x, w_gate, w_up, w_down):
        g = _silu(x @ w_gate)
        u = x @ w_up
        return (g * u) @ w_down

    x = A_q
    g = _sigmoid((x * gate_w).sum(-1, keepdims=True))
    a = _A_ref(x, A_k, A_v, A_shift_k, A_ssm_k, A_ssm_D)
    b = _B_ref(x, B_w_gate, B_w_up, B_w_down)
    return g * a + (1 - g) * b
```

```asm
; @launch grid=(256,1,1) block=(256,1,1) lds=163840
.amdgcn_target "amdgcn-amd-amdhsa--gfx950"
.text
.globl gated_mix__ssm_conv_h3__swiglu_ffn__prompt_kernel
.p2align 8
.type gated_mix__ssm_conv_h3__swiglu_ffn__prompt_kernel,@function
gated_mix__ssm_conv_h3__swiglu_ffn__prompt_kernel:
    s_cmp_ge_u32 s2, 256
    s_cbranch_scc1 L_end
    s_load_dwordx16 s[40:55], s[0:1], 0
    s_load_dwordx8 s[56:63], s[0:1], 64
    s_load_dwordx4 s[64:67], s[0:1], 96
    v_lshrrev_b32 v2, 6, v0
    v_and_b32 v1, 63, v0
    v_readfirstlane_b32 s68, v2
    v_lshlrev_b32 v2, 4, v1
    s_cmp_ge_u32 s2, 224
    s_cbranch_scc1 L_helper
    s_lshr_b32 s69, s2, 3
    s_mul_i32 s75, s69, 37
    s_lshr_b32 s75, s75, 8
    s_mul_i32 s72, s75, 7
    s_sub_u32 s72, s69, s72
    s_and_b32 s70, s2, 7
    s_lshl2_add_u32 s71, s70, s75
    s_lshr_b32 s69, s70, 1
    s_lshl2_add_u32 s69, s69, s75
    s_and_b32 s70, s70, 1
    s_mul_i32 s70, s70, 7
    s_add_u32 s70, s70, s72
    v_lshrrev_b32 v24, 3, v1
    v_mul_u32_u24 v0, 896, v24
    v_and_b32 v29, 7, v1
    v_lshrrev_b32 v28, 4, v1
    v_xor_b32 v30, v29, v28
    v_lshl_add_u32 v3, v30, 4, v0
    v_xor_b32 v30, 4, v30
    v_lshl_add_u32 v4, v30, 4, v0
    v_add_u32 v4, 6144, v4
    v_add_u32 v5, 12288, v3
    v_add_u32 v6, 12288, v4
    s_lshl2_add_u32 s96, s69, s68
    s_mul_i32 s96, s96, 28672
    s_lshl_b32 s95, s68, 12
    s_mov_b32 s6, 1835008
    s_mov_b32 s7, 0x20000
    v_and_b32 v27, 15, v1
    v_mul_u32_u24 v9, 3584, v28
    v_lshlrev_b32 v31, 1, v28
    v_xor_b32 v30, v27, v31
    v_lshl_add_u32 v7, v30, 4, v9
    v_add_u32 v8, 13312, v7
    v_xor_b32 v30, 8, v30
    v_lshl_add_u32 v9, v30, 4, v9
    v_add_u32 v10, 39936, v9
    v_add_u32 v9, 26624, v9
    s_mul_i32 s97, s68, 57344
    s_lshl_b32 s3, s70, 8
    s_add_u32 s97, s97, s3
    s_mov_b32 s10, 1605632
    s_mov_b32 s11, 0x20000
    s_mov_b64 s[14:15], s[10:11]
    s_waitcnt lgkmcnt(0)
    s_mov_b64 s[4:5], s[40:41]
    s_mov_b64 s[8:9], s[54:55]
    s_mov_b64 s[12:13], s[56:57]
    s_add_u32 m0, s95, 0
    s_nop 0
    buffer_load_dwordx4 v3, s[4:7], s96 offen offset:0 lds
    buffer_load_dwordx4 v4, s[4:7], s96 offen offset:1024 lds
    buffer_load_dwordx4 v5, s[4:7], s96 offen offset:2048 lds
    buffer_load_dwordx4 v6, s[4:7], s96 offen offset:3072 lds
    s_add_u32 m0, s95, 49152
    s_nop 0
    buffer_load_dwordx4 v7, s[8:11], s97 offen offset:0 lds
    buffer_load_dwordx4 v8, s[8:11], s97 offen offset:1024 lds
    buffer_load_dwordx4 v9, s[8:11], s97 offen offset:2048 lds
    buffer_load_dwordx4 v10, s[8:11], s97 offen offset:3072 lds
    s_add_u32 m0, s95, 65536
    s_nop 0
    buffer_load_dwordx4 v7, s[12:15], s97 offen offset:0 lds
    buffer_load_dwordx4 v8, s[12:15], s97 offen offset:1024 lds
    buffer_load_dwordx4 v9, s[12:15], s97 offen offset:2048 lds
    buffer_load_dwordx4 v10, s[12:15], s97 offen offset:3072 lds
    s_add_u32 s96, s96, 128
    s_add_u32 s97, s97, 229376
    s_getpc_b64 s[88:89]
L_pcw:
    s_sub_u32 s88, s88, L_pcw-gated_mix__ssm_conv_h3__swiglu_ffn__prompt_kernel
    s_subb_u32 s89, s89, 0
    s_lshr_b32 s3, s2, 3
    s_lshl_b32 s3, s3, 10
    s_lshl_b32 s91, s68, 8
    s_add_u32 s3, s3, s91
    v_and_b32 v31, 1, v1
    v_lshl_add_u32 v31, v31, 7, s3
    v_min_u32 v31, L_codeend-gated_mix__ssm_conv_h3__swiglu_ffn__prompt_kernel-4, v31
    global_load_dword a253, v31, s[88:89]
    s_lshr_b32 s73, s68, 1
    s_and_b32 s74, s68, 1
    s_lshl_b32 s100, s68, 11
    s_lshl_b32 s3, s73, 6
    v_add_u32 v31, s3, v27
    v_lshlrev_b32 v31, 7, v31
    v_lshrrev_b32 v30, 1, v27
    v_xor_b32 v30, v30, v28
    v_lshl_add_u32 v11, v30, 4, v31
    v_xor_b32 v30, 4, v30
    v_lshl_add_u32 v12, v30, 4, v31
    v_bfe_u32 v23, v1, 2, 2
    v_lshl_add_u32 v31, v28, 3, v23
    v_lshlrev_b32 v124, 7, v31
    v_lshlrev_b32 v31, 8, v31
    v_and_b32 v30, 3, v1
    v_lshl_add_u32 v31, v30, 3, v31
    v_add_u32 v31, 49152, v31
    v_and_b32 v30, 1, v28
    v_lshl_or_b32 v30, v30, 2, v23
    s_lshl_b32 s3, s74, 2
    v_xor_b32 v30, s3, v30
    v_xor_b32 v17, 0, v30
    v_lshl_add_u32 v13, v17, 5, v31
    v_xor_b32 v17, 1, v30
    v_lshl_add_u32 v14, v17, 5, v31
    v_xor_b32 v17, 2, v30
    v_lshl_add_u32 v15, v17, 5, v31
    v_xor_b32 v17, 3, v30
    v_lshl_add_u32 v16, v17, 5, v31
    v_add_u32 v17, 0x10000, v13
    v_add_u32 v18, 0x10000, v14
    v_add_u32 v19, 0x10000, v15
    v_add_u32 v20, 0x10000, v16
    s_cmp_eq_u32 s68, 1
    s_cselect_b64 s[32:33], s[56:57], s[54:55]
    s_cmp_ge_u32 s68, 2
    s_cselect_b64 s[32:33], s[40:41], s[32:33]
    s_cselect_b32 s34, s6, s10
    s_mov_b32 s35, 0x20000
    s_mov_b64 s[16:17], s[58:59]
    s_mov_b64 s[18:19], s[10:11]
    s_mov_b64 s[24:25], s[62:63]
    s_mov_b64 s[26:27], s[6:7]
    s_mov_b64 s[36:37], s[64:65]
    s_movk_i32 s38, 256
    s_mov_b32 s39, 0x20000
    s_mov_b64 s[20:21], s[66:67]
    s_mov_b32 s22, 0x1000000
    s_mov_b32 s23, 0x20000
    s_lshl_b32 s75, s72, 5
    s_add_u32 s75, s75, s71
    s_lshl_b32 s3, s75, 2
    s_add_u32 s50, s50, s3
    s_addc_u32 s51, s51, 0
    s_load_dword s85, s[50:51], 0
    s_lshl1_add_u32 s75, s75, s73
    s_lshl_b32 s75, s75, 12
    s_add_u32 s28, s48, s75
    s_addc_u32 s29, s49, 0
    s_sub_u32 s30, 1835008, s75
    s_mov_b32 s31, 0x20000
    s_add_u32 s84, s75, 8388608
    s_add_u32 s0, s66, s84
    s_addc_u32 s1, s67, 0
    s_mov_b64 s[56:57], s[42:43]
    s_mov_b64 s[58:59], s[6:7]
    s_mov_b64 s[60:61], s[44:45]
    s_mov_b64 s[62:63], s[6:7]
    s_mov_b64 s[64:65], s[46:47]
    s_movk_i32 s66, 3584
    s_mov_b32 s67, 0x20000
    s_add_u32 m0, s95, 16384
    s_nop 0
    buffer_load_dwordx4 v3, s[4:7], s96 offen offset:0 lds
    s_lshl1_add_u32 s75, s70, s68
    s_sub_u32 s75, s75, 2
    s_mul_i32 s75, s75, 14
    s_mul_i32 s91, s69, 24
    s_mov_b32 s93, 0x8000
    s_movk_i32 s92, 3584
    buffer_load_dwordx4 v4, s[4:7], s96 offen offset:1024 lds
    s_cmp_ge_u32 s68, 2
    s_cselect_b32 s75, s75, s91
    s_cselect_b32 s91, 13, 23
    s_cmp_ge_u32 s68, 2
    s_cselect_b32 s93, 21846, s93
    s_cselect_b32 s94, 3, 2
    s_cmp_ge_u32 s68, 2
    s_cselect_b32 s92, 896, s92
    v_min_u32 v84, s91, v1
    v_add_u32 v84, s75, v84
    v_mul_u32_u24 v86, s93, v84
    buffer_load_dwordx4 v5, s[4:7], s96 offen offset:2048 lds
    v_lshrrev_b32 v86, 16, v86
    v_mul_u32_u24 v87, s94, v86
    v_sub_u32 v84, v84, v87
    v_mul_u32_u24 v86, s92, v86
    v_lshl_add_u32 v84, v84, 7, v86
    s_lshl_b32 s91, s70, 8
    buffer_load_dwordx4 v6, s[4:7], s96 offen offset:3072 lds
    s_add_u32 s91, s91, 917504
    s_mul_i32 s92, s69, 114688
    s_add_u32 s92, s92, 512
    s_cmp_ge_u32 s68, 2
    s_cselect_b32 s91, s92, s91
    v_add_u32 v84, s91, v84
    s_add_u32 m0, s95, 114688
    s_nop 0
    buffer_load_dwordx4 v7, s[8:11], s97 offen offset:0 lds
    v_and_b32 v30, 2, v24
    v_xor_b32 v30, v29, v30
    v_lshl_add_u32 v96, v30, 4, v0
    v_xor_b32 v30, 4, v30
    v_lshl_add_u32 v97, v30, 4, v0
    v_add_u32 v97, 6144, v97
    buffer_load_dwordx4 v8, s[8:11], s97 offen offset:1024 lds
    s_lshl_b32 s75, s68, 4
    v_add_u32 v25, s75, v27
    v_lshlrev_b32 v101, 3, v25
    s_lshl_b32 s55, s71, 6
    s_add_u32 s54, s55, s75
    s_mul_i32 s54, s54, 896
    buffer_load_dwordx4 v9, s[8:11], s97 offen offset:2048 lds
    s_lshl_b32 s75, s72, 7
    s_add_u32 s54, s54, s75
    s_sub_u32 s55, s55, 3
    s_mul_i32 s55, s55, 896
    s_add_u32 s55, s55, s75
    v_lshl_add_u32 v98, v25, 1, s55
    buffer_load_dwordx4 v10, s[8:11], s97 offen offset:3072 lds
    v_add_u32 v99, 896, v98
    v_add_u32 v100, 1792, v98
    s_lshl_b32 s55, s72, 9
    v_and_b32 v125, 1, v1
    v_lshl_add_u32 v124, v125, 3, v124
    s_add_u32 m0, s95, 131072
    s_nop 0
    buffer_load_dwordx4 v7, s[12:15], s97 offen offset:0 lds
    v_add_u32 v124, 147456, v124
    v_bfe_u32 v125, v1, 1, 1
    s_lshl_b32 s75, s68, 1
    v_or_b32 v125, s75, v125
    v_and_b32 v126, 2, v23
    v_xor_b32 v125, v125, v126
    buffer_load_dwordx4 v8, s[12:15], s97 offen offset:1024 lds
    v_and_b32 v126, 1, v28
    v_lshlrev_b32 v126, 2, v126
    v_xor_b32 v126, v125, v126
    v_lshl_add_u32 v125, v126, 4, v124
    v_xor_b32 v126, 4, v126
    v_lshl_add_u32 v124, v126, 4, v124
    s_waitcnt vmcnt(11)
    s_barrier
    ds_read_b128 v[32:35], v11 offset:0
    ds_read_b64_tr_b16 v[64:65], v13 offset:0
    ds_read_b64_tr_b16 v[66:67], v13 offset:1024
    ds_read_b128 v[36:39], v11 offset:2048
    ds_read_b128 v[40:43], v11 offset:4096
    ds_read_b128 v[44:47], v11 offset:6144
    ds_read_b64_tr_b16 v[68:69], v13 offset:16384
    ds_read_b64_tr_b16 v[70:71], v13 offset:17408
    ds_read_b64_tr_b16 v[72:73], v14 offset:0
    ds_read_b64_tr_b16 v[74:75], v14 offset:1024
    s_waitcnt lgkmcnt(7)
    v_mfma_f32_16x16x32_bf16 v[128:131], v[64:67], v[32:35], 0
    ds_read_b64_tr_b16 v[76:77], v14 offset:16384
    v_subrev_u32 v124, 512, v124
    s_waitcnt lgkmcnt(7)
    v_mfma_f32_16x16x32_bf16 v[144:147], v[64:67], v[36:39], 0
    ds_read_b64_tr_b16 v[78:79], v14 offset:17408
    buffer_load_dwordx4 v9, s[12:15], s97 offen offset:2048 lds
    s_waitcnt lgkmcnt(7)
    v_mfma_f32_16x16x32_bf16 v[160:163], v[64:67], v[40:43], 0
    v_max_u32 v126, 147456, v124
    v_and_b32 v127, 55, v25
    s_waitcnt lgkmcnt(6)
    v_mfma_f32_16x16x32_bf16 v[176:179], v[64:67], v[44:47], 0
    v_lshlrev_b32 v127, 12, v127
    s_waitcnt lgkmcnt(4)
    v_mfma_f32_16x16x32_bf16 v[184:187], v[68:71], v[44:47], 0
    ds_read_b64_tr_b16 v[64:65], v15 offset:0
    v_lshlrev_b32 v31, 4, v28
    v_mfma_f32_16x16x32_bf16 v[168:171], v[68:71], v[40:43], 0
    ds_read_b64_tr_b16 v[66:67], v15 offset:1024
    v_sub_u32 v127, v127, v31
    v_mfma_f32_16x16x32_bf16 v[152:155], v[68:71], v[36:39], 0
    ds_read_b128 v[48:51], v12 offset:0
    buffer_load_dwordx4 v10, s[12:15], s97 offen offset:3072 lds
    s_add_u32 s96, s96, 128
    s_add_u32 s97, s97, 229376
    v_mfma_f32_16x16x32_bf16 v[136:139], v[68:71], v[32:35], 0
    v_bfe_u32 v31, v1, 3, 1
    s_waitcnt lgkmcnt(5)
    v_mfma_f32_16x16x32_bf16 v[132:135], v[72:75], v[32:35], 0
    ds_read_b64_tr_b16 v[68:69], v15 offset:16384
    s_add_u32 m0, s95, 32768
    s_nop 0
    buffer_load_dwordx4 v3, s[4:7], s96 offen offset:0 lds
    v_mfma_f32_16x16x32_bf16 v[148:151], v[72:75], v[36:39], 0
    ds_read_b64_tr_b16 v[70:71], v15 offset:17408
    v_lshlrev_b32 v31, 6, v31
    v_mfma_f32_16x16x32_bf16 v[164:167], v[72:75], v[40:43], 0
    ds_read_b128 v[52:55], v12 offset:2048
    v_sub_u32 v127, v127, v31
    v_mfma_f32_16x16x32_bf16 v[180:183], v[72:75], v[44:47], 0
    s_lshl_b32 s75, s71, 7
    s_sub_u32 s75, 4016, s75
    s_waitcnt lgkmcnt(6)
    v_mfma_f32_16x16x32_bf16 v[188:191], v[76:79], v[44:47], 0
    ds_read_b64_tr_b16 v[72:73], v16 offset:0
    v_add_u32 v127, s75, v127
    v_mfma_f32_16x16x32_bf16 v[172:175], v[76:79], v[40:43], 0
    ds_read_b64_tr_b16 v[74:75], v16 offset:1024
    s_lshl1_add_u32 s75, s69, s73
    v_mfma_f32_16x16x32_bf16 v[156:159], v[76:79], v[36:39], 0
    ds_read_b128 v[56:59], v12 offset:4096
    buffer_load_dwordx4 v4, s[4:7], s96 offen offset:1024 lds
    v_mfma_f32_16x16x32_bf16 v[140:143], v[76:79], v[32:35], 0
    s_mul_i32 s94, s75, 229376
    s_lshl_b32 s91, s75, 2
    s_waitcnt lgkmcnt(7)
    v_mfma_f32_16x16x32_bf16 v[192:195], v[64:67], v[32:35], 0
    ds_read_b64_tr_b16 v[76:77], v16 offset:16384
    s_lshl1_add_u32 s75, s70, s74
    v_mfma_f32_16x16x32_bf16 v[208:211], v[64:67], v[36:39], 0
    ds_read_b64_tr_b16 v[78:79], v16 offset:17408
    s_lshl_b32 s98, s75, 13
    v_mfma_f32_16x16x32_bf16 v[224:227], v[64:67], v[40:43], 0
    ds_read_b128 v[60:63], v12 offset:6144
    s_add_u32 s94, s94, s98
    v_mfma_f32_16x16x32_bf16 v[240:243], v[64:67], v[44:47], 0
    buffer_load_dwordx4 v5, s[4:7], s96 offen offset:2048 lds
    s_waitcnt lgkmcnt(7)
    v_mfma_f32_16x16x32_bf16 v[248:251], v[68:71], v[44:47], 0
    ds_read_b64_tr_b16 v[64:65], v13 offset:8192
    s_add_u32 s98, s94, 4096
    v_mfma_f32_16x16x32_bf16 v[232:235], v[68:71], v[40:43], 0
    ds_read_b64_tr_b16 v[66:67], v13 offset:9216
    s_mul_i32 s75, s75, 37
    v_mfma_f32_16x16x32_bf16 v[216:219], v[68:71], v[36:39], 0
    s_lshr_b32 s75, s75, 8
    s_add_u32 s91, s91, s75
    s_lshl_b32 s91, s91, 7
    v_mfma_f32_16x16x32_bf16 v[200:203], v[68:71], v[32:35], 0
    s_add_u32 s91, s91, 12648448
    s_lshl_b32 s69, s72, 18
    s_waitcnt lgkmcnt(6)
    v_mfma_f32_16x16x32_bf16 v[196:199], v[72:75], v[32:35], 0
    ds_read_b64_tr_b16 v[68:69], v13 offset:24576
    buffer_load_dwordx4 v6, s[4:7], s96 offen offset:3072 lds
    v_mfma_f32_16x16x32_bf16 v[212:215], v[72:75], v[36:39], 0
    ds_read_b64_tr_b16 v[70:71], v13 offset:25600
    s_add_u32 s69, s69, 8388608
    v_mfma_f32_16x16x32_bf16 v[228:231], v[72:75], v[40:43], 0
    s_lshl2_add_u32 s70, s72, s68
    s_lshl_b32 s70, s70, 7
    s_add_u32 s70, s70, 12668928
    v_mfma_f32_16x16x32_bf16 v[244:247], v[72:75], v[44:47], 0
    s_lshl2_add_u32 s90, s71, s68
    s_lshl_b32 s90, s90, 7
    s_waitcnt lgkmcnt(5)
    v_mfma_f32_16x16x32_bf16 v[252:255], v[76:79], v[44:47], 0
    ds_read_b64_tr_b16 v[72:73], v14 offset:8192
    s_add_u32 s90, s90, 12648448
    v_mfma_f32_16x16x32_bf16 v[236:239], v[76:79], v[40:43], 0
    ds_read_b64_tr_b16 v[74:75], v14 offset:9216
    s_lshr_b32 s75, s71, 3
    v_mfma_f32_16x16x32_bf16 v[220:223], v[76:79], v[36:39], 0
    s_add_u32 m0, s95, 81920
    s_nop 0
    buffer_load_dwordx4 v7, s[8:11], s97 offen offset:0 lds
    v_mfma_f32_16x16x32_bf16 v[204:207], v[76:79], v[32:35], 0
    s_lshl2_add_u32 s75, s72, s75
    s_lshl_b32 s75, s75, 7
    s_waitcnt lgkmcnt(4)
    v_mfma_f32_16x16x32_bf16 v[128:131], v[64:67], v[48:51], v[128:131]
    ds_read_b64_tr_b16 v[76:77], v14 offset:24576
    s_add_u32 s99, s75, 12668928
    v_mfma_f32_16x16x32_bf16 v[144:147], v[64:67], v[52:55], v[144:147]
    ds_read_b64_tr_b16 v[78:79], v14 offset:25600
    s_mul_i32 s92, s71, 229376
    v_mfma_f32_16x16x32_bf16 v[160:163], v[64:67], v[56:59], v[160:163]
    s_mul_i32 s75, s68, 57344
    s_add_u32 s92, s92, s75
    s_lshl_b32 s75, s74, 11
    v_mfma_f32_16x16x32_bf16 v[176:179], v[64:67], v[60:63], v[176:179]
    buffer_load_dwordx4 v8, s[8:11], s97 offen offset:1024 lds
    s_waitcnt lgkmcnt(4)
    v_mfma_f32_16x16x32_bf16 v[184:187], v[68:71], v[60:63], v[184:187]
    ds_read_b64_tr_b16 v[64:65], v15 offset:8192
    s_add_u32 s84, s84, s75
    v_mfma_f32_16x16x32_bf16 v[168:171], v[68:71], v[56:59], v[168:171]
    ds_read_b64_tr_b16 v[66:67], v15 offset:9216
    s_add_u32 s84, s84, 2097152
    v_mfma_f32_16x16x32_bf16 v[152:155], v[68:71], v[52:55], v[152:155]
    s_mov_b32 s88, 0xbfb8aa3b
    s_mov_b32 s89, 0xbfb8aa3b
    v_mfma_f32_16x16x32_bf16 v[136:139], v[68:71], v[48:51], v[136:139]
    v_lshlrev_b32 v31, 1, v28
    s_waitcnt lgkmcnt(4)
    v_mfma_f32_16x16x32_bf16 v[132:135], v[72:75], v[48:51], v[132:135]
    ds_read_b64_tr_b16 v[68:69], v15 offset:24576
    buffer_load_dwordx4 v9, s[8:11], s97 offen offset:2048 lds
    v_mfma_f32_16x16x32_bf16 v[148:151], v[72:75], v[52:55], v[148:151]
    ds_read_b64_tr_b16 v[70:71], v15 offset:25600
    buffer_load_dword a252, v84, s[32:35], 0 offen
    v_mfma_f32_16x16x32_bf16 v[164:167], v[72:75], v[56:59], v[164:167]
    v_xor_b32 v31, v29, v31
    v_lshl_add_u32 v21, v31, 4, v0
    v_mfma_f32_16x16x32_bf16 v[180:183], v[72:75], v[60:63], v[180:183]
    v_add_u32 v22, 6144, v21
    s_waitcnt lgkmcnt(4)
    v_mfma_f32_16x16x32_bf16 v[188:191], v[76:79], v[60:63], v[188:191]
    ds_read_b64_tr_b16 v[72:73], v16 offset:8192
    v_add_u32 v92, 12288, v21
    v_mfma_f32_16x16x32_bf16 v[172:175], v[76:79], v[56:59], v[172:175]
    ds_read_b64_tr_b16 v[74:75], v16 offset:9216
    buffer_load_dwordx4 v10, s[8:11], s97 offen offset:3072 lds
    v_mfma_f32_16x16x32_bf16 v[156:159], v[76:79], v[52:55], v[156:159]
    v_add_u32 v93, 18432, v21
    v_and_b32 v30, 3, v1
    v_mfma_f32_16x16x32_bf16 v[140:143], v[76:79], v[48:51], v[140:143]
    v_lshlrev_b32 v30, 3, v30
    s_waitcnt lgkmcnt(4)
    v_mfma_f32_16x16x32_bf16 v[192:195], v[64:67], v[48:51], v[192:195]
    ds_read_b64_tr_b16 v[76:77], v16 offset:24576
    v_lshl_add_u32 v31, v28, 2, v23
    v_mfma_f32_16x16x32_bf16 v[208:211], v[64:67], v[52:55], v[208:211]
    ds_read_b64_tr_b16 v[78:79], v16 offset:25600
    v_lshl_add_u32 v0, v31, 6, v30
    v_mfma_f32_16x16x32_bf16 v[224:227], v[64:67], v[56:59], v[224:227]
    v_bfe_u32 v24, v31, 1, 2
    v_lshl_add_u32 v31, v31, 7, v30
    v_mfma_f32_16x16x32_bf16 v[240:243], v[64:67], v[60:63], v[240:243]
    s_add_u32 m0, s95, 98304
    s_nop 0
    buffer_load_dwordx4 v7, s[12:15], s97 offen offset:0 lds
    s_waitcnt lgkmcnt(4)
    v_mfma_f32_16x16x32_bf16 v[248:251], v[68:71], v[60:63], v[248:251]
    s_lshl_b32 s75, s68, 13
    s_add_u32 s101, s75, 49152
    v_mfma_f32_16x16x32_bf16 v[232:235], v[68:71], v[56:59], v[232:235]
    v_add_u32 v31, s101, v31
    v_lshl_add_u32 v23, v24, 5, v31
    s_waitcnt vmcnt(10) lgkmcnt(0)
    s_barrier
    v_mfma_f32_16x16x32_bf16 v[216:219], v[68:71], v[52:55], v[216:219]
    ds_read_b128 v[32:35], v11 offset:16384
    v_xor_b32 v24, 32, v23
    v_mfma_f32_16x16x32_bf16 v[200:203], v[68:71], v[48:51], v[200:203]
    ds_read_b64_tr_b16 v[64:65], v17 offset:0
    v_mfma_f32_16x16x32_bf16 v[196:199], v[72:75], v[48:51], v[196:199]
    ds_read_b64_tr_b16 v[66:67], v17 offset:1024
    buffer_load_dwordx4 v8, s[12:15], s97 offen offset:1024 lds
    v_mfma_f32_16x16x32_bf16 v[212:215], v[72:75], v[52:55], v[212:215]
    ds_read_b128 v[36:39], v11 offset:18432
    s_mul_i32 s40, s68, 401408
    v_mfma_f32_16x16x32_bf16 v[228:231], v[72:75], v[56:59], v[228:231]
    ds_read_b128 v[40:43], v11 offset:20480
    s_lshl_b32 s75, s72, 7
    v_mfma_f32_16x16x32_bf16 v[244:247], v[72:75], v[60:63], v[244:247]
    ds_read_b128 v[44:47], v11 offset:22528
    v_mfma_f32_16x16x32_bf16 v[252:255], v[76:79], v[60:63], v[252:255]
    ds_read_b64_tr_b16 v[68:69], v17 offset:16384
    s_add_u32 s40, s40, s75
    v_mfma_f32_16x16x32_bf16 v[236:239], v[76:79], v[56:59], v[236:239]
    ds_read_b64_tr_b16 v[70:71], v17 offset:17408
    buffer_load_dwordx4 v9, s[12:15], s97 offen offset:2048 lds
    v_mfma_f32_16x16x32_bf16 v[220:223], v[76:79], v[52:55], v[220:223]
    ds_read_b64_tr_b16 v[72:73], v18 offset:0
    s_add_u32 s41, s40, 28672
    v_mfma_f32_16x16x32_bf16 v[204:207], v[76:79], v[48:51], v[204:207]
    ds_read_b64_tr_b16 v[74:75], v18 offset:1024
    s_waitcnt lgkmcnt(7)
    v_mfma_f32_16x16x32_bf16 v[128:131], v[64:67], v[32:35], v[128:131]
    ds_read_b64_tr_b16 v[76:77], v18 offset:16384
    s_add_u32 s42, s41, 28672
    s_waitcnt lgkmcnt(7)
    v_mfma_f32_16x16x32_bf16 v[144:147], v[64:67], v[36:39], v[144:147]
    ds_read_b64_tr_b16 v[78:79], v18 offset:17408
    s_add_u32 s43, s42, 28672
    s_waitcnt lgkmcnt(7)
    v_mfma_f32_16x16x32_bf16 v[160:163], v[64:67], v[40:43], v[160:163]
    buffer_load_dwordx4 v10, s[12:15], s97 offen offset:3072 lds
    s_add_u32 s96, s96, 128
    s_add_u32 s97, s97, 229376
    s_waitcnt lgkmcnt(6)
    v_mfma_f32_16x16x32_bf16 v[176:179], v[64:67], v[44:47], v[176:179]
    s_add_u32 m0, s100, 147456
    s_nop 0
    buffer_load_dwordx4 v96, s[56:59], s54 offen lds
    s_waitcnt lgkmcnt(4)
    v_mfma_f32_16x16x32_bf16 v[184:187], v[68:71], v[44:47], v[184:187]
    ds_read_b64_tr_b16 v[64:65], v19 offset:0
    s_add_u32 s44, s43, 28672
    v_mfma_f32_16x16x32_bf16 v[168:171], v[68:71], v[40:43], v[168:171]
    ds_read_b64_tr_b16 v[66:67], v19 offset:1024
    s_add_u32 s45, s44, 28672
    v_mfma_f32_16x16x32_bf16 v[152:155], v[68:71], v[36:39], v[152:155]
    ds_read_b128 v[48:51], v12 offset:16384
    s_add_u32 s46, s45, 28672
    v_mfma_f32_16x16x32_bf16 v[136:139], v[68:71], v[32:35], v[136:139]
    buffer_load_dwordx4 v97, s[56:59], s54 offen offset:1024 lds
    s_waitcnt lgkmcnt(5)
    v_mfma_f32_16x16x32_bf16 v[132:135], v[72:75], v[32:35], v[132:135]
    ds_read_b64_tr_b16 v[68:69], v19 offset:16384
    s_add_u32 s47, s46, 28672
    v_mfma_f32_16x16x32_bf16 v[148:151], v[72:75], v[36:39], v[148:151]
    ds_read_b64_tr_b16 v[70:71], v19 offset:17408
    s_add_u32 s48, s47, 28672
    v_mfma_f32_16x16x32_bf16 v[164:167], v[72:75], v[40:43], v[164:167]
    ds_read_b128 v[52:55], v12 offset:18432
    s_add_u32 s49, s48, 28672
    v_mfma_f32_16x16x32_bf16 v[180:183], v[72:75], v[44:47], v[180:183]
    s_add_u32 m0, s100, 155648
    s_nop 0
    buffer_load_dwordx4 v96, s[60:63], s54 offen lds
    s_waitcnt lgkmcnt(6)
    v_mfma_f32_16x16x32_bf16 v[188:191], v[76:79], v[44:47], v[188:191]
    ds_read_b64_tr_b16 v[72:73], v20 offset:0
    s_add_u32 s50, s49, 28672
    v_mfma_f32_16x16x32_bf16 v[172:175], v[76:79], v[40:43], v[172:175]
    ds_read_b64_tr_b16 v[74:75], v20 offset:1024
    s_add_u32 s51, s50, 28672
    v_mfma_f32_16x16x32_bf16 v[156:159], v[76:79], v[36:39], v[156:159]
    ds_read_b128 v[56:59], v12 offset:20480
    s_add_u32 s52, s51, 28672
    v_mfma_f32_16x16x32_bf16 v[140:143], v[76:79], v[32:35], v[140:143]
    buffer_load_dwordx4 v97, s[60:63], s54 offen offset:1024 lds
    s_waitcnt lgkmcnt(7)
    v_mfma_f32_16x16x32_bf16 v[192:195], v[64:67], v[32:35], v[192:195]
    ds_read_b64_tr_b16 v[76:77], v20 offset:16384
    s_add_u32 s53, s52, 28672
    v_mfma_f32_16x16x32_bf16 v[208:211], v[64:67], v[36:39], v[208:211]
    ds_read_b64_tr_b16 v[78:79], v20 offset:17408
    v_lshrrev_b32 v29, 1, v27
    v_mfma_f32_16x16x32_bf16 v[224:227], v[64:67], v[40:43], v[224:227]
    ds_read_b128 v[60:63], v12 offset:22528
    v_xor_b32 v29, s74, v29
    v_mfma_f32_16x16x32_bf16 v[240:243], v[64:67], v[44:47], v[240:243]
    buffer_load_dwordx2 v[116:117], v101, s[64:67], s55 offen
    s_waitcnt lgkmcnt(7)
    v_mfma_f32_16x16x32_bf16 v[248:251], v[68:71], v[44:47], v[248:251]
    ds_read_b64_tr_b16 v[64:65], v17 offset:8192
    v_lshlrev_b32 v29, 6, v29
    v_mfma_f32_16x16x32_bf16 v[232:235], v[68:71], v[40:43], v[232:235]
    ds_read_b64_tr_b16 v[66:67], v17 offset:9216
    v_lshlrev_b32 v30, 4, v28
    v_mfma_f32_16x16x32_bf16 v[216:219], v[68:71], v[36:39], v[216:219]
    v_sub_u32 v25, v30, v29
    v_and_b32 v29, 1, v27
    v_mfma_f32_16x16x32_bf16 v[200:203], v[68:71], v[32:35], v[200:203]
    buffer_load_ushort v122, v98, s[56:59], 0 offen
    s_waitcnt lgkmcnt(6)
    v_mfma_f32_16x16x32_bf16 v[196:199], v[72:75], v[32:35], v[196:199]
    ds_read_b64_tr_b16 v[68:69], v17 offset:24576
    v_xor_b32 v29, 1, v29
    v_mfma_f32_16x16x32_bf16 v[212:215], v[72:75], v[36:39], v[212:215]
    ds_read_b64_tr_b16 v[70:71], v17 offset:25600
    v_mul_u32_u24 v29, 4640, v29
    v_mfma_f32_16x16x32_bf16 v[228:231], v[72:75], v[40:43], v[228:231]
    v_add_u32 v25, v25, v29
    s_mul_i32 s86, s73, 9472
    v_mfma_f32_16x16x32_bf16 v[244:247], v[72:75], v[44:47], v[244:247]
    buffer_load_ushort v123, v99, s[56:59], 0 offen
    s_waitcnt lgkmcnt(5)
    v_mfma_f32_16x16x32_bf16 v[252:255], v[76:79], v[44:47], v[252:255]
    ds_read_b64_tr_b16 v[72:73], v18 offset:8192
    s_add_u32 s86, s86, 20992
    v_mfma_f32_16x16x32_bf16 v[236:239], v[76:79], v[40:43], v[236:239]
    ds_read_b64_tr_b16 v[74:75], v18 offset:9216
    s_lshl_b32 s93, s74, 8
    v_mfma_f32_16x16x32_bf16 v[220:223], v[76:79], v[36:39], v[220:223]
    s_add_u32 s75, s86, s93
    s_add_u32 s75, s75, 448
    v_mfma_f32_16x16x32_bf16 v[204:207], v[76:79], v[32:35], v[204:207]
    buffer_load_ushort v80, v100, s[56:59], 0 offen
    s_waitcnt lgkmcnt(4)
    v_mfma_f32_16x16x32_bf16 v[128:131], v[64:67], v[48:51], v[128:131]
    ds_read_b64_tr_b16 v[76:77], v18 offset:24576
    v_add_u32 v25, s75, v25
    v_mfma_f32_16x16x32_bf16 v[144:147], v[64:67], v[52:55], v[144:147]
    ds_read_b64_tr_b16 v[78:79], v18 offset:25600
    s_mul_i32 s75, s74, 4640
    v_mfma_f32_16x16x32_bf16 v[160:163], v[64:67], v[56:59], v[160:163]
    s_add_u32 s75, s75, s86
    v_lshl_add_u32 v83, v1, 3, s75
    v_mfma_f32_16x16x32_bf16 v[176:179], v[64:67], v[60:63], v[176:179]
    v_add_u32 v31, 1, v27
    s_waitcnt lgkmcnt(4)
    v_mfma_f32_16x16x32_bf16 v[184:187], v[68:71], v[60:63], v[184:187]
    ds_read_b64_tr_b16 v[64:65], v19 offset:8192
    s_add_u32 m0, s95, 0
    s_nop 0
    buffer_load_dwordx4 v3, s[4:7], s96 offen offset:0 lds
    v_mfma_f32_16x16x32_bf16 v[168:171], v[68:71], v[56:59], v[168:171]
    ds_read_b64_tr_b16 v[66:67], v19 offset:9216
    v_and_b32 v29, 3, v31
    v_mfma_f32_16x16x32_bf16 v[152:155], v[68:71], v[52:55], v[152:155]
    v_lshrrev_b32 v31, 2, v31
    v_lshl_add_u32 v26, v31, 4, v30
    v_mfma_f32_16x16x32_bf16 v[136:139], v[68:71], v[48:51], v[136:139]
    buffer_load_dwordx4 v4, s[4:7], s96 offen offset:1024 lds
    s_waitcnt lgkmcnt(4)
    v_mfma_f32_16x16x32_bf16 v[132:135], v[72:75], v[48:51], v[132:135]
    ds_read_b64_tr_b16 v[68:69], v19 offset:24576
    v_mul_u32_u24 v31, 4160, v29
    v_mfma_f32_16x16x32_bf16 v[148:151], v[72:75], v[52:55], v[148:151]
    ds_read_b64_tr_b16 v[70:71], v19 offset:25600
    buffer_load_dwordx4 v5, s[4:7], s96 offen offset:2048 lds
    v_mfma_f32_16x16x32_bf16 v[164:167], v[72:75], v[56:59], v[164:167]
    v_add_u32 v26, v26, v31
    v_min_u32 v31, 1, v29
    v_mfma_f32_16x16x32_bf16 v[180:183], v[72:75], v[60:63], v[180:183]
    v_lshl_add_u32 v26, v31, 4, v26
    s_waitcnt lgkmcnt(4)
    v_mfma_f32_16x16x32_bf16 v[188:191], v[76:79], v[60:63], v[188:191]
    ds_read_b64_tr_b16 v[72:73], v20 offset:8192
    buffer_load_dwordx4 v6, s[4:7], s96 offen offset:3072 lds
    v_mfma_f32_16x16x32_bf16 v[172:175], v[76:79], v[56:59], v[172:175]
    ds_read_b64_tr_b16 v[74:75], v20 offset:9216
    s_mul_i32 s86, s73, 16656
    v_mfma_f32_16x16x32_bf16 v[156:159], v[76:79], v[52:55], v[156:159]
    s_add_u32 m0, s95, 49152
    s_nop 0
    buffer_load_dwordx4 v7, s[8:11], s97 offen offset:0 lds
    v_mfma_f32_16x16x32_bf16 v[140:143], v[76:79], v[48:51], v[140:143]
    s_add_u32 s86, s86, 114688
    s_add_u32 s75, s86, s93
    s_waitcnt lgkmcnt(4)
    v_mfma_f32_16x16x32_bf16 v[192:195], v[64:67], v[48:51], v[192:195]
    ds_read_b64_tr_b16 v[76:77], v20 offset:24576
    buffer_load_dwordx4 v8, s[8:11], s97 offen offset:1024 lds
    v_mfma_f32_16x16x32_bf16 v[208:211], v[64:67], v[52:55], v[208:211]
    ds_read_b64_tr_b16 v[78:79], v20 offset:25600
    v_add_u32 v26, s75, v26
    v_mfma_f32_16x16x32_bf16 v[224:227], v[64:67], v[56:59], v[224:227]
    s_mul_i32 s87, s73, -127232
    v_add_u32 v31, s87, v26
    v_mfma_f32_16x16x32_bf16 v[240:243], v[64:67], v[60:63], v[240:243]
    buffer_load_dwordx4 v9, s[8:11], s97 offen offset:2048 lds
    s_waitcnt lgkmcnt(4)
    v_mfma_f32_16x16x32_bf16 v[248:251], v[68:71], v[60:63], v[248:251]
    v_cmp_eq_u32 vcc, 3, v29
    s_nop 1
    v_cndmask_b32 v26, v26, v31, vcc
    v_mfma_f32_16x16x32_bf16 v[232:235], v[68:71], v[56:59], v[232:235]
    buffer_load_dwordx4 v10, s[8:11], s97 offen offset:3072 lds
    v_mul_u32_u24 v82, 4160, v28
    s_waitcnt vmcnt(16) lgkmcnt(0)
    s_barrier
    v_mfma_f32_16x16x32_bf16 v[216:219], v[68:71], v[52:55], v[216:219]
    ds_read_b128 v[32:35], v11 offset:32768
    v_min_u32 v30, 1, v28
    v_mfma_f32_16x16x32_bf16 v[200:203], v[68:71], v[48:51], v[200:203]
    ds_read_b64_tr_b16 v[64:65], v13 offset:32768
    v_mfma_f32_16x16x32_bf16 v[196:199], v[72:75], v[48:51], v[196:199]
    ds_read_b64_tr_b16 v[66:67], v13 offset:33792
    s_add_u32 m0, s95, 65536
    s_nop 0
    buffer_load_dwordx4 v7, s[12:15], s97 offen offset:0 lds
    v_mfma_f32_16x16x32_bf16 v[212:215], v[72:75], v[52:55], v[212:215]
    ds_read_b128 v[36:39], v11 offset:34816
    v_lshl_add_u32 v82, v30, 4, v82
    v_mfma_f32_16x16x32_bf16 v[228:231], v[72:75], v[56:59], v[228:231]
    ds_read_b128 v[40:43], v11 offset:36864
    buffer_load_dwordx4 v8, s[12:15], s97 offen offset:1024 lds
    v_mfma_f32_16x16x32_bf16 v[244:247], v[72:75], v[60:63], v[244:247]
    ds_read_b128 v[44:47], v11 offset:38912
    v_mfma_f32_16x16x32_bf16 v[252:255], v[76:79], v[60:63], v[252:255]
    ds_read_b64_tr_b16 v[68:69], v13 offset:49152
    buffer_load_dwordx4 v9, s[12:15], s97 offen offset:2048 lds
    v_mfma_f32_16x16x32_bf16 v[236:239], v[76:79], v[56:59], v[236:239]
    ds_read_b64_tr_b16 v[70:71], v13 offset:50176
    v_lshl_add_u32 v82, v27, 2, v82
    v_mfma_f32_16x16x32_bf16 v[220:223], v[76:79], v[52:55], v[220:223]
    ds_read_b64_tr_b16 v[72:73], v14 offset:32768
    buffer_load_dwordx4 v10, s[12:15], s97 offen offset:3072 lds
    s_add_u32 s96, s96, 128
    s_add_u32 s97, s97, 229376
    v_mfma_f32_16x16x32_bf16 v[204:207], v[76:79], v[48:51], v[204:207]
    ds_read_b64_tr_b16 v[74:75], v14 offset:33792
    s_waitcnt lgkmcnt(7)
    v_mfma_f32_16x16x32_bf16 v[128:131], v[64:67], v[32:35], v[128:131]
    ds_read_b64_tr_b16 v[76:77], v14 offset:49152
    s_add_u32 m0, s95, 16384
    s_nop 0
    buffer_load_dwordx4 v3, s[4:7], s96 offen offset:0 lds
    s_waitcnt lgkmcnt(7)
    v_mfma_f32_16x16x32_bf16 v[144:147], v[64:67], v[36:39], v[144:147]
    ds_read_b64_tr_b16 v[78:79], v14 offset:50176
    v_add_u32 v82, s86, v82
    s_waitcnt lgkmcnt(7)
    v_mfma_f32_16x16x32_bf16 v[160:163], v[64:67], v[40:43], v[160:163]
    v_add_u32 v30, s87, v82
    s_waitcnt lgkmcnt(6)
    v_mfma_f32_16x16x32_bf16 v[176:179], v[64:67], v[44:47], v[176:179]
    s_waitcnt lgkmcnt(4)
    v_mfma_f32_16x16x32_bf16 v[184:187], v[68:71], v[44:47], v[184:187]
    ds_read_b64_tr_b16 v[64:65], v15 offset:32768
    v_mfma_f32_16x16x32_bf16 v[168:171], v[68:71], v[40:43], v[168:171]
    ds_read_b64_tr_b16 v[66:67], v15 offset:33792
    v_mfma_f32_16x16x32_bf16 v[152:155], v[68:71], v[36:39], v[152:155]
    ds_read_b128 v[48:51], v12 offset:32768
    buffer_load_dwordx4 v4, s[4:7], s96 offen offset:1024 lds
    v_mfma_f32_16x16x32_bf16 v[136:139], v[68:71], v[32:35], v[136:139]
    s_waitcnt lgkmcnt(5)
    v_mfma_f32_16x16x32_bf16 v[132:135], v[72:75], v[32:35], v[132:135]
    ds_read_b64_tr_b16 v[68:69], v15 offset:49152
    v_mfma_f32_16x16x32_bf16 v[148:151], v[72:75], v[36:39], v[148:151]
    ds_read_b64_tr_b16 v[70:71], v15 offset:50176
    v_mfma_f32_16x16x32_bf16 v[164:167], v[72:75], v[40:43], v[164:167]
    ds_read_b128 v[52:55], v12 offset:34816
    v_mfma_f32_16x16x32_bf16 v[180:183], v[72:75], v[44:47], v[180:183]
    buffer_load_dwordx4 v5, s[4:7], s96 offen offset:2048 lds
    s_waitcnt lgkmcnt(6)
    v_mfma_f32_16x16x32_bf16 v[188:191], v[76:79], v[44:47], v[188:191]
    ds_read_b64_tr_b16 v[72:73], v16 offset:32768
    v_mfma_f32_16x16x32_bf16 v[172:175], v[76:79], v[40:43], v[172:175]
    ds_read_b64_tr_b16 v[74:75], v16 offset:33792
    v_mfma_f32_16x16x32_bf16 v[156:159], v[76:79], v[36:39], v[156:159]
    ds_read_b128 v[56:59], v12 offset:36864
    v_mfma_f32_16x16x32_bf16 v[140:143], v[76:79], v[32:35], v[140:143]
    s_waitcnt lgkmcnt(7)
    v_mfma_f32_16x16x32_bf16 v[192:195], v[64:67], v[32:35], v[192:195]
    ds_read_b64_tr_b16 v[76:77], v16 offset:49152
    buffer_load_dwordx4 v6, s[4:7], s96 offen offset:3072 lds
    v_mfma_f32_16x16x32_bf16 v[208:211], v[64:67], v[36:39], v[208:211]
    ds_read_b64_tr_b16 v[78:79], v16 offset:50176
    v_mfma_f32_16x16x32_bf16 v[224:227], v[64:67], v[40:43], v[224:227]
    ds_read_b128 v[60:63], v12 offset:38912
    v_mfma_f32_16x16x32_bf16 v[240:243], v[64:67], v[44:47], v[240:243]
    s_waitcnt lgkmcnt(7)
    v_mfma_f32_16x16x32_bf16 v[248:251], v[68:71], v[44:47], v[248:251]
    ds_read_b64_tr_b16 v[64:65], v13 offset:40960
    v_mfma_f32_16x16x32_bf16 v[232:235], v[68:71], v[40:43], v[232:235]
    ds_read_b64_tr_b16 v[66:67], v13 offset:41984
    v_mfma_f32_16x16x32_bf16 v[216:219], v[68:71], v[36:39], v[216:219]
    s_add_u32 m0, s95, 114688
    s_nop 0
    buffer_load_dwordx4 v7, s[8:11], s97 offen offset:0 lds
    v_mfma_f32_16x16x32_bf16 v[200:203], v[68:71], v[32:35], v[200:203]
    s_waitcnt lgkmcnt(6)
    v_mfma_f32_16x16x32_bf16 v[196:199], v[72:75], v[32:35], v[196:199]
    ds_read_b64_tr_b16 v[68:69], v13 offset:57344
    v_mfma_f32_16x16x32_bf16 v[212:215], v[72:75], v[36:39], v[212:215]
    ds_read_b64_tr_b16 v[70:71], v13 offset:58368
    v_mfma_f32_16x16x32_bf16 v[228:231], v[72:75], v[40:43], v[228:231]
    v_cmp_eq_u32 vcc, 3, v28
    s_nop 1
    v_cndmask_b32 v82, v82, v30, vcc
    v_mfma_f32_16x16x32_bf16 v[244:247], v[72:75], v[44:47], v[244:247]
    buffer_load_dwordx4 v8, s[8:11], s97 offen offset:1024 lds
    s_waitcnt lgkmcnt(5)
    v_mfma_f32_16x16x32_bf16 v[252:255], v[76:79], v[44:47], v[252:255]
    ds_read_b64_tr_b16 v[72:73], v14 offset:40960
    s_mul_i32 s75, s74, 8336
    v_mfma_f32_16x16x32_bf16 v[236:239], v[76:79], v[40:43], v[236:239]
    ds_read_b64_tr_b16 v[74:75], v14 offset:41984
    s_add_u32 s86, s86, s75
    v_mfma_f32_16x16x32_bf16 v[220:223], v[76:79], v[36:39], v[220:223]
    s_mul_i32 s87, s74, s87
    s_add_u32 s87, s87, s86
    s_lshl_b32 s75, s74, 4
    v_mfma_f32_16x16x32_bf16 v[204:207], v[76:79], v[32:35], v[204:207]
    s_sub_u32 s87, s87, s75
    s_lshl_b32 s93, s74, 3
    s_waitcnt lgkmcnt(4)
    v_mfma_f32_16x16x32_bf16 v[128:131], v[64:67], v[48:51], v[128:131]
    ds_read_b64_tr_b16 v[76:77], v14 offset:57344
    buffer_load_dwordx4 v9, s[8:11], s97 offen offset:2048 lds
    v_mfma_f32_16x16x32_bf16 v[144:147], v[64:67], v[52:55], v[144:147]
    ds_read_b64_tr_b16 v[78:79], v14 offset:58368
    s_waitcnt lgkmcnt(0)
    s_lshl_b32 s75, s73, 4
    s_lshr_b32 s85, s85, s75
    v_mfma_f32_16x16x32_bf16 v[160:163], v[64:67], v[56:59], v[160:163]
    s_and_b32 s85, s85, 0xffff
    s_cmp_eq_u32 s74, 0
    s_cselect_b32 s85, s85, 0
    v_mfma_f32_16x16x32_bf16 v[176:179], v[64:67], v[60:63], v[176:179]
    v_lshl_add_u32 v29, v28, 2, v27
    v_mfma_f32_16x16x32_bf16 v[184:187], v[68:71], v[60:63], v[184:187]
    ds_read_b64_tr_b16 v[64:65], v15 offset:40960
    v_mov_b32 v30, s85
    v_mfma_f32_16x16x32_bf16 v[168:171], v[68:71], v[56:59], v[168:171]
    ds_read_b64_tr_b16 v[66:67], v15 offset:41984
    buffer_load_dwordx4 v10, s[8:11], s97 offen offset:3072 lds
    v_mfma_f32_16x16x32_bf16 v[152:155], v[68:71], v[52:55], v[152:155]
    v_cmp_eq_u32 vcc, 15, v29
    s_nop 1
    v_cndmask_b32 v31, 0, v30, vcc
    v_mfma_f32_16x16x32_bf16 v[136:139], v[68:71], v[48:51], v[136:139]
    v_accvgpr_write_b32 a224, v31
    v_mfma_f32_16x16x32_bf16 v[132:135], v[72:75], v[48:51], v[132:135]
    ds_read_b64_tr_b16 v[68:69], v15 offset:57344
    v_mfma_f32_16x16x32_bf16 v[148:151], v[72:75], v[52:55], v[148:151]
    ds_read_b64_tr_b16 v[70:71], v15 offset:58368
    v_mfma_f32_16x16x32_bf16 v[164:167], v[72:75], v[56:59], v[164:167]
    v_cmp_eq_u32 vcc, 14, v29
    s_nop 1
    v_cndmask_b32 v31, 0, v30, vcc
    v_mfma_f32_16x16x32_bf16 v[180:183], v[72:75], v[60:63], v[180:183]
    s_add_u32 m0, s95, 131072
    s_nop 0
    buffer_load_dwordx4 v7, s[12:15], s97 offen offset:0 lds
    v_mfma_f32_16x16x32_bf16 v[188:191], v[76:79], v[60:63], v[188:191]
    ds_read_b64_tr_b16 v[72:73], v16 offset:40960
    v_accvgpr_write_b32 a225, v31
    v_mfma_f32_16x16x32_bf16 v[172:175], v[76:79], v[56:59], v[172:175]
    ds_read_b64_tr_b16 v[74:75], v16 offset:41984
    v_mfma_f32_16x16x32_bf16 v[156:159], v[76:79], v[52:55], v[156:159]
    v_cmp_eq_u32 vcc, 13, v29
    s_nop 1
    v_cndmask_b32 v31, 0, v30, vcc
    v_mfma_f32_16x16x32_bf16 v[140:143], v[76:79], v[48:51], v[140:143]
    v_accvgpr_write_b32 a226, v31
    s_waitcnt lgkmcnt(4)
    v_mfma_f32_16x16x32_bf16 v[192:195], v[64:67], v[48:51], v[192:195]
    ds_read_b64_tr_b16 v[76:77], v16 offset:57344
    buffer_load_dwordx4 v8, s[12:15], s97 offen offset:1024 lds
    v_mfma_f32_16x16x32_bf16 v[208:211], v[64:67], v[52:55], v[208:211]
    ds_read_b64_tr_b16 v[78:79], v16 offset:58368
    v_mfma_f32_16x16x32_bf16 v[224:227], v[64:67], v[56:59], v[224:227]
    v_cmp_eq_u32 vcc, 12, v29
    s_nop 1
    v_cndmask_b32 v31, 0, v30, vcc
    v_mfma_f32_16x16x32_bf16 v[240:243], v[64:67], v[60:63], v[240:243]
    v_accvgpr_write_b32 a227, v31
    s_waitcnt lgkmcnt(4)
    v_mfma_f32_16x16x32_bf16 v[248:251], v[68:71], v[60:63], v[248:251]
    v_mfma_f32_16x16x32_bf16 v[232:235], v[68:71], v[56:59], v[232:235]
    buffer_load_dwordx4 v9, s[12:15], s97 offen offset:2048 lds
    s_waitcnt vmcnt(11) lgkmcnt(0)
    s_barrier
    v_mfma_f32_16x16x32_bf16 v[216:219], v[68:71], v[52:55], v[216:219]
    ds_read_b128 v[32:35], v11 offset:0
    ds_read_b64_tr_b16 v[96:97], v126 offset:0
    v_mfma_f32_16x16x32_bf16 v[200:203], v[68:71], v[48:51], v[200:203]
    ds_read_b64_tr_b16 v[64:65], v13 offset:0
    v_mfma_f32_16x16x32_bf16 v[196:199], v[72:75], v[48:51], v[196:199]
    ds_read_b64_tr_b16 v[66:67], v13 offset:1024
    ds_read_b64_tr_b16 v[98:99], v125 offset:0
    v_mfma_f32_16x16x32_bf16 v[212:215], v[72:75], v[52:55], v[212:215]
    ds_read_b128 v[36:39], v11 offset:2048
    ds_read_b64_tr_b16 v[100:101], v125 offset:512
    v_mfma_f32_16x16x32_bf16 v[228:231], v[72:75], v[56:59], v[228:231]
    ds_read_b128 v[40:43], v11 offset:4096
    buffer_load_dwordx4 v10, s[12:15], s97 offen offset:3072 lds
    s_add_u32 s96, s96, 128
    s_add_u32 s97, s97, 229376
    v_mfma_f32_16x16x32_bf16 v[244:247], v[72:75], v[60:63], v[244:247]
    ds_read_b128 v[44:47], v11 offset:6144
    v_mfma_f32_16x16x32_bf16 v[252:255], v[76:79], v[60:63], v[252:255]
    ds_read_b64_tr_b16 v[68:69], v13 offset:16384
    s_add_u32 m0, s95, 32768
    s_nop 0
    buffer_load_dwordx4 v3, s[4:7], s96 offen offset:0 lds
    v_mfma_f32_16x16x32_bf16 v[236:239], v[76:79], v[56:59], v[236:239]
    ds_read_b64_tr_b16 v[70:71], v13 offset:17408
    ds_read_b64_tr_b16 v[102:103], v125 offset:8192
    v_mfma_f32_16x16x32_bf16 v[220:223], v[76:79], v[52:55], v[220:223]
    ds_read_b64_tr_b16 v[72:73], v14 offset:0
    ds_read_b64_tr_b16 v[104:105], v125 offset:8704
    v_mfma_f32_16x16x32_bf16 v[204:207], v[76:79], v[48:51], v[204:207]
    ds_read_b64_tr_b16 v[74:75], v14 offset:1024
    s_waitcnt lgkmcnt(11)
    v_mfma_f32_16x16x32_bf16 v[128:131], v[64:67], v[32:35], v[128:131]
    ds_read_b64_tr_b16 v[76:77], v14 offset:16384
    ds_read_b64_tr_b16 v[106:107], v124 offset:4096
    s_waitcnt lgkmcnt(11)
    v_mfma_f32_16x16x32_bf16 v[144:147], v[64:67], v[36:39], v[144:147]
    ds_read_b64_tr_b16 v[78:79], v14 offset:17408
    ds_read_b64_tr_b16 v[108:109], v125 offset:4096
    s_waitcnt lgkmcnt(11)
    v_mfma_f32_16x16x32_bf16 v[160:163], v[64:67], v[40:43], v[160:163]
    buffer_load_dwordx4 v4, s[4:7], s96 offen offset:1024 lds
    ds_read_b64_tr_b16 v[110:111], v125 offset:4608
    s_waitcnt lgkmcnt(11)
    v_mfma_f32_16x16x32_bf16 v[176:179], v[64:67], v[44:47], v[176:179]
    ds_read_b64_tr_b16 v[112:113], v125 offset:12288
    s_waitcnt lgkmcnt(10)
    v_mfma_f32_16x16x32_bf16 v[184:187], v[68:71], v[44:47], v[184:187]
    ds_read_b64_tr_b16 v[64:65], v15 offset:0
    ds_read_b64_tr_b16 v[114:115], v125 offset:12800
    v_mfma_f32_16x16x32_bf16 v[168:171], v[68:71], v[40:43], v[168:171]
    ds_read_b64_tr_b16 v[66:67], v15 offset:1024
    v_lshlrev_b32 v118, 16, v116
    v_mfma_f32_16x16x32_bf16 v[152:155], v[68:71], v[36:39], v[152:155]
    ds_read_b128 v[48:51], v12 offset:0
    v_and_b32 v119, 0xffff0000, v116
    v_mfma_f32_16x16x32_bf16 v[136:139], v[68:71], v[32:35], v[136:139]
    buffer_load_dwordx4 v5, s[4:7], s96 offen offset:2048 lds
    s_waitcnt lgkmcnt(10)
    v_mfma_f32_16x16x32_bf16 v[132:135], v[72:75], v[32:35], v[132:135]
    ds_read_b64_tr_b16 v[68:69], v15 offset:16384
    v_lshlrev_b32 v120, 16, v117
    v_mfma_f32_16x16x32_bf16 v[148:151], v[72:75], v[36:39], v[148:151]
    ds_read_b64_tr_b16 v[70:71], v15 offset:17408
    v_and_b32 v121, 0xffff0000, v117
    v_mfma_f32_16x16x32_bf16 v[164:167], v[72:75], v[40:43], v[164:167]
    ds_read_b128 v[52:55], v12 offset:2048
    v_lshlrev_b32 v122, 16, v122
    v_mfma_f32_16x16x32_bf16 v[180:183], v[72:75], v[44:47], v[180:183]
    v_lshl_or_b32 v123, v80, 16, v123
    s_waitcnt lgkmcnt(10)
    v_mfma_f32_16x16x32_bf16 v[188:191], v[76:79], v[44:47], v[188:191]
    ds_read_b64_tr_b16 v[72:73], v16 offset:0
    buffer_load_dwordx4 v6, s[4:7], s96 offen offset:3072 lds
    v_mfma_f32_16x16x32_bf16 v[172:175], v[76:79], v[40:43], v[172:175]
    ds_read_b64_tr_b16 v[74:75], v16 offset:1024
    v_mfma_f32_16x16x32_bf16 v[156:159], v[76:79], v[36:39], v[156:159]
    ds_read_b128 v[56:59], v12 offset:4096
    v_mfma_f32_16x16x32_bf16 v[140:143], v[76:79], v[32:35], v[140:143]
    s_waitcnt lgkmcnt(7)
    v_mfma_f32_16x16x32_bf16 v[192:195], v[64:67], v[32:35], v[192:195]
    ds_read_b64_tr_b16 v[76:77], v16 offset:16384
    v_mfma_f32_16x16x32_bf16 v[208:211], v[64:67], v[36:39], v[208:211]
    ds_read_b64_tr_b16 v[78:79], v16 offset:17408
    v_mfma_f32_16x16x32_bf16 v[224:227], v[64:67], v[40:43], v[224:227]
    ds_read_b128 v[60:63], v12 offset:6144
    s_add_u32 m0, s95, 81920
    s_nop 0
    buffer_load_dwordx4 v7, s[8:11], s97 offen offset:0 lds
    v_mfma_f32_16x16x32_bf16 v[240:243], v[64:67], v[44:47], v[240:243]
    s_waitcnt lgkmcnt(7)
    v_mfma_f32_16x16x32_bf16 v[248:251], v[68:71], v[44:47], v[248:251]
    ds_read_b64_tr_b16 v[64:65], v13 offset:8192
    v_mfma_f32_16x16x32_bf16 v[232:235], v[68:71], v[40:43], v[232:235]
    ds_read_b64_tr_b16 v[66:67], v13 offset:9216
    v_mfma_f32_16x16x32_bf16 v[216:219], v[68:71], v[36:39], v[216:219]
    v_cmp_gt_u32 vcc, 16, v1
    s_nop 1
    v_cndmask_b32 v96, v96, v122, vcc
    v_cndmask_b32 v97, v97, v123, vcc
    v_mfma_f32_16x16x32_bf16 v[200:203], v[68:71], v[32:35], v[200:203]
    buffer_load_dwordx4 v8, s[8:11], s97 offen offset:1024 lds
    s_waitcnt lgkmcnt(6)
    v_mfma_f32_16x16x32_bf16 v[196:199], v[72:75], v[32:35], v[196:199]
    ds_read_b64_tr_b16 v[68:69], v13 offset:24576
    v_and_b32 v95, 0xffff0000, v96
    v_mfma_f32_16x16x32_bf16 v[212:215], v[72:75], v[36:39], v[212:215]
    ds_read_b64_tr_b16 v[70:71], v13 offset:25600
    v_mul_f32 v84, v121, v95
    v_mfma_f32_16x16x32_bf16 v[228:231], v[72:75], v[40:43], v[228:231]
    v_lshlrev_b32 v94, 16, v97
    v_fmac_f32 v84, v120, v94
    v_mfma_f32_16x16x32_bf16 v[244:247], v[72:75], v[44:47], v[244:247]
    v_mul_f32 v85, v121, v94
    s_waitcnt lgkmcnt(5)
    v_mfma_f32_16x16x32_bf16 v[252:255], v[76:79], v[44:47], v[252:255]
    ds_read_b64_tr_b16 v[72:73], v14 offset:8192
    buffer_load_dwordx4 v9, s[8:11], s97 offen offset:2048 lds
    v_mfma_f32_16x16x32_bf16 v[236:239], v[76:79], v[40:43], v[236:239]
    ds_read_b64_tr_b16 v[74:75], v14 offset:9216
    v_and_b32 v95, 0xffff0000, v97
    v_mfma_f32_16x16x32_bf16 v[220:223], v[76:79], v[36:39], v[220:223]
    v_fmac_f32 v84, v119, v95
    v_fmac_f32 v85, v120, v95
    v_mfma_f32_16x16x32_bf16 v[204:207], v[76:79], v[32:35], v[204:207]
    v_mul_f32 v86, v121, v95
    s_waitcnt lgkmcnt(4)
    v_mfma_f32_16x16x32_bf16 v[128:131], v[64:67], v[48:51], v[128:131]
    ds_read_b64_tr_b16 v[76:77], v14 offset:24576
    v_lshlrev_b32 v94, 16, v98
    v_mfma_f32_16x16x32_bf16 v[144:147], v[64:67], v[52:55], v[144:147]
    ds_read_b64_tr_b16 v[78:79], v14 offset:25600
    buffer_load_dwordx4 v10, s[8:11], s97 offen offset:3072 lds
    v_mfma_f32_16x16x32_bf16 v[160:163], v[64:67], v[56:59], v[160:163]
    v_fmac_f32 v84, v118, v94
    v_fmac_f32 v85, v119, v94
    v_mfma_f32_16x16x32_bf16 v[176:179], v[64:67], v[60:63], v[176:179]
    v_fmac_f32 v86, v120, v94
    s_waitcnt lgkmcnt(4)
    v_mfma_f32_16x16x32_bf16 v[184:187], v[68:71], v[60:63], v[184:187]
    ds_read_b64_tr_b16 v[64:65], v15 offset:8192
    v_mul_f32 v87, v121, v94
    v_mfma_f32_16x16x32_bf16 v[168:171], v[68:71], v[56:59], v[168:171]
    ds_read_b64_tr_b16 v[66:67], v15 offset:9216
    v_and_b32 v95, 0xffff0000, v98
    v_mfma_f32_16x16x32_bf16 v[152:155], v[68:71], v[52:55], v[152:155]
    v_fmac_f32 v85, v118, v95
    v_fmac_f32 v86, v119, v95
    v_mfma_f32_16x16x32_bf16 v[136:139], v[68:71], v[48:51], v[136:139]
    s_add_u32 m0, s95, 98304
    s_nop 0
    buffer_load_dwordx4 v7, s[12:15], s97 offen offset:0 lds
    s_waitcnt lgkmcnt(4)
    v_mfma_f32_16x16x32_bf16 v[132:135], v[72:75], v[48:51], v[132:135]
    ds_read_b64_tr_b16 v[68:69], v15 offset:24576
    v_fmac_f32 v87, v120, v95
    v_mfma_f32_16x16x32_bf16 v[148:151], v[72:75], v[52:55], v[148:151]
    ds_read_b64_tr_b16 v[70:71], v15 offset:25600
    v_mul_f32 v88, v121, v95
    v_mfma_f32_16x16x32_bf16 v[164:167], v[72:75], v[56:59], v[164:167]
    v_lshlrev_b32 v94, 16, v99
    v_fmac_f32 v86, v118, v94
    v_mfma_f32_16x16x32_bf16 v[180:183], v[72:75], v[60:63], v[180:183]
    v_fmac_f32 v87, v119, v94
    s_waitcnt lgkmcnt(4)
    v_mfma_f32_16x16x32_bf16 v[188:191], v[76:79], v[60:63], v[188:191]
    ds_read_b64_tr_b16 v[72:73], v16 offset:8192
    buffer_load_dwordx4 v8, s[12:15], s97 offen offset:1024 lds
    v_mfma_f32_16x16x32_bf16 v[172:175], v[76:79], v[56:59], v[172:175]
    ds_read_b64_tr_b16 v[74:75], v16 offset:9216
    v_fmac_f32 v88, v120, v94
    v_mfma_f32_16x16x32_bf16 v[156:159], v[76:79], v[52:55], v[156:159]
    v_mul_f32 v89, v121, v94
    v_and_b32 v95, 0xffff0000, v99
    v_mfma_f32_16x16x32_bf16 v[140:143], v[76:79], v[48:51], v[140:143]
    v_fmac_f32 v87, v118, v95
    s_waitcnt lgkmcnt(4)
    v_mfma_f32_16x16x32_bf16 v[192:195], v[64:67], v[48:51], v[192:195]
    ds_read_b64_tr_b16 v[76:77], v16 offset:24576
    v_fmac_f32 v88, v119, v95
    v_mfma_f32_16x16x32_bf16 v[208:211], v[64:67], v[52:55], v[208:211]
    ds_read_b64_tr_b16 v[78:79], v16 offset:25600
    buffer_load_dwordx4 v9, s[12:15], s97 offen offset:2048 lds
    v_mfma_f32_16x16x32_bf16 v[224:227], v[64:67], v[56:59], v[224:227]
    v_fmac_f32 v89, v120, v95
    v_mul_f32 v90, v121, v95
    v_mfma_f32_16x16x32_bf16 v[240:243], v[64:67], v[60:63], v[240:243]
    v_lshlrev_b32 v94, 16, v100
    s_waitcnt lgkmcnt(4)
    v_mfma_f32_16x16x32_bf16 v[248:251], v[68:71], v[60:63], v[248:251]
    v_fmac_f32 v88, v118, v94
    v_fmac_f32 v89, v119, v94
    v_mfma_f32_16x16x32_bf16 v[232:235], v[68:71], v[56:59], v[232:235]
    v_fmac_f32 v90, v120, v94
    v_mul_f32 v91, v121, v94
    s_waitcnt vmcnt(11) lgkmcnt(0)
    s_barrier
    v_mfma_f32_16x16x32_bf16 v[216:219], v[68:71], v[52:55], v[216:219]
    ds_read_b128 v[32:35], v11 offset:16384
    buffer_load_dwordx4 v10, s[12:15], s97 offen offset:3072 lds
    s_add_u32 s96, s96, 128
    s_add_u32 s97, s97, 229376
    v_mfma_f32_16x16x32_bf16 v[200:203], v[68:71], v[48:51], v[200:203]
    ds_read_b64_tr_b16 v[64:65], v17 offset:0
    v_mfma_f32_16x16x32_bf16 v[196:199], v[72:75], v[48:51], v[196:199]
    ds_read_b64_tr_b16 v[66:67], v17 offset:1024
    v_and_b32 v95, 0xffff0000, v100
    v_mfma_f32_16x16x32_bf16 v[212:215], v[72:75], v[52:55], v[212:215]
    ds_read_b128 v[36:39], v11 offset:18432
    v_fmac_f32 v89, v118, v95
    v_mfma_f32_16x16x32_bf16 v[228:231], v[72:75], v[56:59], v[228:231]
    ds_read_b128 v[40:43], v11 offset:20480
    v_fmac_f32 v90, v119, v95
    v_mfma_f32_16x16x32_bf16 v[244:247], v[72:75], v[60:63], v[244:247]
    ds_read_b128 v[44:47], v11 offset:22528
    v_mfma_f32_16x16x32_bf16 v[252:255], v[76:79], v[60:63], v[252:255]
    ds_read_b64_tr_b16 v[68:69], v17 offset:16384
    s_add_u32 m0, s95, 0
    s_nop 0
    buffer_load_dwordx4 v3, s[4:7], s96 offen offset:0 lds
    v_mfma_f32_16x16x32_bf16 v[236:239], v[76:79], v[56:59], v[236:239]
    ds_read_b64_tr_b16 v[70:71], v17 offset:17408
    v_fmac_f32 v91, v120, v95
    v_mfma_f32_16x16x32_bf16 v[220:223], v[76:79], v[52:55], v[220:223]
    ds_read_b64_tr_b16 v[72:73], v18 offset:0
    v_lshlrev_b32 v94, 16, v101
    v_mfma_f32_16x16x32_bf16 v[204:207], v[76:79], v[48:51], v[204:207]
    ds_read_b64_tr_b16 v[74:75], v18 offset:1024
    s_waitcnt lgkmcnt(7)
    v_mfma_f32_16x16x32_bf16 v[128:131], v[64:67], v[32:35], v[128:131]
    ds_read_b64_tr_b16 v[76:77], v18 offset:16384
    v_fmac_f32 v90, v118, v94
    s_waitcnt lgkmcnt(7)
    v_mfma_f32_16x16x32_bf16 v[144:147], v[64:67], v[36:39], v[144:147]
    ds_read_b64_tr_b16 v[78:79], v18 offset:17408
    buffer_load_dwordx4 v4, s[4:7], s96 offen offset:1024 lds
    s_waitcnt lgkmcnt(7)
    v_mfma_f32_16x16x32_bf16 v[160:163], v[64:67], v[40:43], v[160:163]
    v_fmac_f32 v91, v119, v94
    v_and_b32 v95, 0xffff0000, v101
    s_waitcnt lgkmcnt(6)
    v_mfma_f32_16x16x32_bf16 v[176:179], v[64:67], v[44:47], v[176:179]
    v_fmac_f32 v91, v118, v95
    s_waitcnt lgkmcnt(4)
    v_mfma_f32_16x16x32_bf16 v[184:187], v[68:71], v[44:47], v[184:187]
    ds_read_b64_tr_b16 v[64:65], v19 offset:0
    v_lshlrev_b32 v94, 16, v102
    v_mfma_f32_16x16x32_bf16 v[168:171], v[68:71], v[40:43], v[168:171]
    ds_read_b64_tr_b16 v[66:67], v19 offset:1024
    v_and_b32 v95, 0xffff0000, v102
    v_mfma_f32_16x16x32_bf16 v[152:155], v[68:71], v[36:39], v[152:155]
    ds_read_b128 v[48:51], v12 offset:16384
    buffer_load_dwordx4 v5, s[4:7], s96 offen offset:2048 lds
    v_mfma_f32_16x16x32_bf16 v[136:139], v[68:71], v[32:35], v[136:139]
    v_mul_f32 v84, v84, v94
    s_waitcnt lgkmcnt(5)
    v_mfma_f32_16x16x32_bf16 v[132:135], v[72:75], v[32:35], v[132:135]
    ds_read_b64_tr_b16 v[68:69], v19 offset:16384
    v_mul_f32 v85, v85, v95
    v_mfma_f32_16x16x32_bf16 v[148:151], v[72:75], v[36:39], v[148:151]
    ds_read_b64_tr_b16 v[70:71], v19 offset:17408
    v_lshlrev_b32 v94, 16, v103
    v_mfma_f32_16x16x32_bf16 v[164:167], v[72:75], v[40:43], v[164:167]
    ds_read_b128 v[52:55], v12 offset:18432
    v_and_b32 v95, 0xffff0000, v103
    v_mfma_f32_16x16x32_bf16 v[180:183], v[72:75], v[44:47], v[180:183]
    v_mul_f32 v86, v86, v94
    s_waitcnt lgkmcnt(6)
    v_mfma_f32_16x16x32_bf16 v[188:191], v[76:79], v[44:47], v[188:191]
    ds_read_b64_tr_b16 v[72:73], v20 offset:0
    buffer_load_dwordx4 v6, s[4:7], s96 offen offset:3072 lds
    v_mfma_f32_16x16x32_bf16 v[172:175], v[76:79], v[40:43], v[172:175]
    ds_read_b64_tr_b16 v[74:75], v20 offset:1024
    v_mul_f32 v87, v87, v95
    v_mfma_f32_16x16x32_bf16 v[156:159], v[76:79], v[36:39], v[156:159]
    ds_read_b128 v[56:59], v12 offset:20480
    v_lshlrev_b32 v94, 16, v104
    v_mfma_f32_16x16x32_bf16 v[140:143], v[76:79], v[32:35], v[140:143]
    v_and_b32 v95, 0xffff0000, v104
    s_waitcnt lgkmcnt(7)
    v_mfma_f32_16x16x32_bf16 v[192:195], v[64:67], v[32:35], v[192:195]
    ds_read_b64_tr_b16 v[76:77], v20 offset:16384
    v_mul_f32 v88, v88, v94
    v_mfma_f32_16x16x32_bf16 v[208:211], v[64:67], v[36:39], v[208:211]
    ds_read_b64_tr_b16 v[78:79], v20 offset:17408
    s_add_u32 m0, s95, 49152
    s_nop 0
    buffer_load_dwordx4 v7, s[8:11], s97 offen offset:0 lds
    v_mfma_f32_16x16x32_bf16 v[224:227], v[64:67], v[40:43], v[224:227]
    ds_read_b128 v[60:63], v12 offset:22528
    v_mul_f32 v89, v89, v95
    v_mfma_f32_16x16x32_bf16 v[240:243], v[64:67], v[44:47], v[240:243]
    v_lshlrev_b32 v94, 16, v105
    s_waitcnt lgkmcnt(7)
    v_mfma_f32_16x16x32_bf16 v[248:251], v[68:71], v[44:47], v[248:251]
    ds_read_b64_tr_b16 v[64:65], v17 offset:8192
    v_and_b32 v95, 0xffff0000, v105
    v_mfma_f32_16x16x32_bf16 v[232:235], v[68:71], v[40:43], v[232:235]
    ds_read_b64_tr_b16 v[66:67], v17 offset:9216
    v_mul_f32 v90, v90, v94
    v_mfma_f32_16x16x32_bf16 v[216:219], v[68:71], v[36:39], v[216:219]
    buffer_load_dwordx4 v8, s[8:11], s97 offen offset:1024 lds
    v_mul_f32 v91, v91, v95
    v_mfma_f32_16x16x32_bf16 v[200:203], v[68:71], v[32:35], v[200:203]
    v_cvt_pk_bf16_f32 v96, v91, v90
    s_waitcnt lgkmcnt(6)
    v_mfma_f32_16x16x32_bf16 v[196:199], v[72:75], v[32:35], v[196:199]
    ds_read_b64_tr_b16 v[68:69], v17 offset:24576
    v_cvt_pk_bf16_f32 v97, v89, v88
    v_mfma_f32_16x16x32_bf16 v[212:215], v[72:75], v[36:39], v[212:215]
    ds_read_b64_tr_b16 v[70:71], v17 offset:25600
    v_cvt_pk_bf16_f32 v98, v87, v86
    v_mfma_f32_16x16x32_bf16 v[228:231], v[72:75], v[40:43], v[228:231]
    v_cvt_pk_bf16_f32 v99, v85, v84
    v_and_b32 v95, 0xffff0000, v106
    v_mfma_f32_16x16x32_bf16 v[244:247], v[72:75], v[44:47], v[244:247]
    v_mul_f32 v84, v121, v95
    s_waitcnt lgkmcnt(5)
    v_mfma_f32_16x16x32_bf16 v[252:255], v[76:79], v[44:47], v[252:255]
    ds_read_b64_tr_b16 v[72:73], v18 offset:8192
    buffer_load_dwordx4 v9, s[8:11], s97 offen offset:2048 lds
    v_mfma_f32_16x16x32_bf16 v[236:239], v[76:79], v[40:43], v[236:239]
    ds_read_b64_tr_b16 v[74:75], v18 offset:9216
    v_lshlrev_b32 v94, 16, v107
    v_mfma_f32_16x16x32_bf16 v[220:223], v[76:79], v[36:39], v[220:223]
    v_fmac_f32 v84, v120, v94
    v_mul_f32 v85, v121, v94
    v_mfma_f32_16x16x32_bf16 v[204:207], v[76:79], v[32:35], v[204:207]
    v_and_b32 v95, 0xffff0000, v107
    s_waitcnt lgkmcnt(4)
    v_mfma_f32_16x16x32_bf16 v[128:131], v[64:67], v[48:51], v[128:131]
    ds_read_b64_tr_b16 v[76:77], v18 offset:24576
    v_fmac_f32 v84, v119, v95
    v_mfma_f32_16x16x32_bf16 v[144:147], v[64:67], v[52:55], v[144:147]
    ds_read_b64_tr_b16 v[78:79], v18 offset:25600
    buffer_load_dwordx4 v10, s[8:11], s97 offen offset:3072 lds
    v_mfma_f32_16x16x32_bf16 v[160:163], v[64:67], v[56:59], v[160:163]
    v_fmac_f32 v85, v120, v95
    v_mul_f32 v86, v121, v95
    v_mfma_f32_16x16x32_bf16 v[176:179], v[64:67], v[60:63], v[176:179]
    v_lshlrev_b32 v94, 16, v108
    s_waitcnt lgkmcnt(4)
    v_mfma_f32_16x16x32_bf16 v[184:187], v[68:71], v[60:63], v[184:187]
    ds_read_b64_tr_b16 v[64:65], v19 offset:8192
    v_fmac_f32 v84, v118, v94
    v_mfma_f32_16x16x32_bf16 v[168:171], v[68:71], v[56:59], v[168:171]
    ds_read_b64_tr_b16 v[66:67], v19 offset:9216
    v_fmac_f32 v85, v119, v94
    v_mfma_f32_16x16x32_bf16 v[152:155], v[68:71], v[52:55], v[152:155]
    s_add_u32 m0, s95, 65536
    s_nop 0
    buffer_load_dwordx4 v7, s[12:15], s97 offen offset:0 lds
    v_mfma_f32_16x16x32_bf16 v[136:139], v[68:71], v[48:51], v[136:139]
    v_fmac_f32 v86, v120, v94
    s_waitcnt lgkmcnt(4)
    v_mfma_f32_16x16x32_bf16 v[132:135], v[72:75], v[48:51], v[132:135]
    ds_read_b64_tr_b16 v[68:69], v19 offset:24576
    v_mul_f32 v87, v121, v94
    v_mfma_f32_16x16x32_bf16 v[148:151], v[72:75], v[52:55], v[148:151]
    ds_read_b64_tr_b16 v[70:71], v19 offset:25600
    v_and_b32 v95, 0xffff0000, v108
    v_mfma_f32_16x16x32_bf16 v[164:167], v[72:75], v[56:59], v[164:167]
    v_fmac_f32 v85, v118, v95
    v_fmac_f32 v86, v119, v95
    v_mfma_f32_16x16x32_bf16 v[180:183], v[72:75], v[60:63], v[180:183]
    v_fmac_f32 v87, v120, v95
    s_waitcnt lgkmcnt(4)
    v_mfma_f32_16x16x32_bf16 v[188:191], v[76:79], v[60:63], v[188:191]
    ds_read_b64_tr_b16 v[72:73], v20 offset:8192
    buffer_load_dwordx4 v8, s[12:15], s97 offen offset:1024 lds
    v_mfma_f32_16x16x32_bf16 v[172:175], v[76:79], v[56:59], v[172:175]
    ds_read_b64_tr_b16 v[74:75], v20 offset:9216
    v_mul_f32 v88, v121, v95
    v_mfma_f32_16x16x32_bf16 v[156:159], v[76:79], v[52:55], v[156:159]
    v_lshlrev_b32 v94, 16, v109
    v_fmac_f32 v86, v118, v94
    v_mfma_f32_16x16x32_bf16 v[140:143], v[76:79], v[48:51], v[140:143]
    v_fmac_f32 v87, v119, v94
    s_waitcnt lgkmcnt(4)
    v_mfma_f32_16x16x32_bf16 v[192:195], v[64:67], v[48:51], v[192:195]
    ds_read_b64_tr_b16 v[76:77], v20 offset:24576
    v_fmac_f32 v88, v120, v94
    v_mfma_f32_16x16x32_bf16 v[208:211], v[64:67], v[52:55], v[208:211]
    ds_read_b64_tr_b16 v[78:79], v20 offset:25600
    buffer_load_dwordx4 v9, s[12:15], s97 offen offset:2048 lds
    v_mfma_f32_16x16x32_bf16 v[224:227], v[64:67], v[56:59], v[224:227]
    v_mul_f32 v89, v121, v94
    v_and_b32 v95, 0xffff0000, v109
    v_mfma_f32_16x16x32_bf16 v[240:243], v[64:67], v[60:63], v[240:243]
    v_fmac_f32 v87, v118, v95
    s_waitcnt lgkmcnt(4)
    v_mfma_f32_16x16x32_bf16 v[248:251], v[68:71], v[60:63], v[248:251]
    v_fmac_f32 v88, v119, v95
    v_fmac_f32 v89, v120, v95
    v_mfma_f32_16x16x32_bf16 v[232:235], v[68:71], v[56:59], v[232:235]
    v_mul_f32 v90, v121, v95
    v_lshlrev_b32 v94, 16, v110
    s_waitcnt vmcnt(11) lgkmcnt(0)
    s_barrier
    v_mfma_f32_16x16x32_bf16 v[216:219], v[68:71], v[52:55], v[216:219]
    ds_read_b128 v[32:35], v11 offset:32768
    buffer_load_dwordx4 v10, s[12:15], s97 offen offset:3072 lds
    v_mfma_f32_16x16x32_bf16 v[200:203], v[68:71], v[48:51], v[200:203]
    ds_read_b64_tr_b16 v[64:65], v13 offset:32768
    v_mfma_f32_16x16x32_bf16 v[196:199], v[72:75], v[48:51], v[196:199]
    ds_read_b64_tr_b16 v[66:67], v13 offset:33792
    v_fmac_f32 v88, v118, v94
    v_mfma_f32_16x16x32_bf16 v[212:215], v[72:75], v[52:55], v[212:215]
    ds_read_b128 v[36:39], v11 offset:34816
    v_fmac_f32 v89, v119, v94
    v_mfma_f32_16x16x32_bf16 v[228:231], v[72:75], v[56:59], v[228:231]
    ds_read_b128 v[40:43], v11 offset:36864
    v_fmac_f32 v90, v120, v94
    v_mfma_f32_16x16x32_bf16 v[244:247], v[72:75], v[60:63], v[244:247]
    ds_read_b128 v[44:47], v11 offset:38912
    v_mfma_f32_16x16x32_bf16 v[252:255], v[76:79], v[60:63], v[252:255]
    ds_read_b64_tr_b16 v[68:69], v13 offset:49152
    v_add_lshl_u32 v31, v27, v28, 2
    v_subrev_u32 v31, 64, v31
    buffer_load_dword v80, v31, s[28:31], 0 offen
    v_mfma_f32_16x16x32_bf16 v[236:239], v[76:79], v[56:59], v[236:239]
    ds_read_b64_tr_b16 v[70:71], v13 offset:50176
    v_mul_f32 v91, v121, v94
    v_mfma_f32_16x16x32_bf16 v[220:223], v[76:79], v[52:55], v[220:223]
    ds_read_b64_tr_b16 v[72:73], v14 offset:32768
    v_and_b32 v95, 0xffff0000, v110
    v_mfma_f32_16x16x32_bf16 v[204:207], v[76:79], v[48:51], v[204:207]
    ds_read_b64_tr_b16 v[74:75], v14 offset:33792
    s_waitcnt lgkmcnt(7)
    v_mfma_f32_16x16x32_bf16 v[128:131], v[64:67], v[32:35], v[128:131]
    ds_read_b64_tr_b16 v[76:77], v14 offset:49152
    v_fmac_f32 v89, v118, v95
    s_waitcnt lgkmcnt(7)
    v_mfma_f32_16x16x32_bf16 v[144:147], v[64:67], v[36:39], v[144:147]
    ds_read_b64_tr_b16 v[78:79], v14 offset:50176
    v_fmac_f32 v90, v119, v95
    s_waitcnt lgkmcnt(7)
    v_mfma_f32_16x16x32_bf16 v[160:163], v[64:67], v[40:43], v[160:163]
    s_add_u32 m0, s86, 64
    s_nop 0
    buffer_load_dwordx4 v2, s[28:31], s93 offen offset:0 lds
    s_waitcnt lgkmcnt(6)
    v_mfma_f32_16x16x32_bf16 v[176:179], v[64:67], v[44:47], v[176:179]
    v_fmac_f32 v91, v120, v95
    s_waitcnt lgkmcnt(4)
    v_mfma_f32_16x16x32_bf16 v[184:187], v[68:71], v[44:47], v[184:187]
    ds_read_b64_tr_b16 v[64:65], v15 offset:32768
    v_lshlrev_b32 v94, 16, v111
    v_mfma_f32_16x16x32_bf16 v[168:171], v[68:71], v[40:43], v[168:171]
    ds_read_b64_tr_b16 v[66:67], v15 offset:33792
    v_fmac_f32 v90, v118, v94
    v_mfma_f32_16x16x32_bf16 v[152:155], v[68:71], v[36:39], v[152:155]
    ds_read_b128 v[48:51], v12 offset:32768
    v_fmac_f32 v91, v119, v94
    v_mfma_f32_16x16x32_bf16 v[136:139], v[68:71], v[32:35], v[136:139]
    v_and_b32 v95, 0xffff0000, v111
    s_waitcnt lgkmcnt(5)
    v_mfma_f32_16x16x32_bf16 v[132:135], v[72:75], v[32:35], v[132:135]
    ds_read_b64_tr_b16 v[68:69], v15 offset:49152
    buffer_load_dwordx4 v2, s[28:31], s93 offen offset:1024 lds
    v_mfma_f32_16x16x32_bf16 v[148:151], v[72:75], v[36:39], v[148:151]
    ds_read_b64_tr_b16 v[70:71], v15 offset:50176
    v_fmac_f32 v91, v118, v95
    v_mfma_f32_16x16x32_bf16 v[164:167], v[72:75], v[40:43], v[164:167]
    ds_read_b128 v[52:55], v12 offset:34816
    v_lshlrev_b32 v94, 16, v112
    v_and_b32 v95, 0xffff0000, v112
    v_mul_f32 v84, v84, v94
    v_mul_f32 v85, v85, v95
    v_lshlrev_b32 v94, 16, v113
    v_and_b32 v95, 0xffff0000, v113
    v_mul_f32 v86, v86, v94
    v_mul_f32 v87, v87, v95
    v_lshlrev_b32 v94, 16, v114
    v_and_b32 v95, 0xffff0000, v114
    v_mul_f32 v88, v88, v94
    v_mul_f32 v89, v89, v95
    v_lshlrev_b32 v94, 16, v115
    v_and_b32 v95, 0xffff0000, v115
    v_mul_f32 v90, v90, v94
    v_mul_f32 v91, v91, v95
    v_cvt_pk_bf16_f32 v106, v91, v90
    v_cvt_pk_bf16_f32 v107, v89, v88
    v_cvt_pk_bf16_f32 v108, v87, v86
    v_cvt_pk_bf16_f32 v109, v85, v84
    v_mov_b32 v84, v96
    v_mov_b32 v85, v97
    v_mov_b32 v86, v98
    v_mov_b32 v87, v99
    v_mov_b32_dpp v96, v106 row_ror:8 row_mask:0xf bank_mask:0xc
    v_mov_b32_dpp v97, v107 row_ror:8 row_mask:0xf bank_mask:0xc
    v_mov_b32_dpp v98, v108 row_ror:8 row_mask:0xf bank_mask:0xc
    v_mov_b32_dpp v99, v109 row_ror:8 row_mask:0xf bank_mask:0xc
    v_mov_b32_dpp v106, v84 row_ror:8 row_mask:0xf bank_mask:0x3
    v_mov_b32_dpp v107, v85 row_ror:8 row_mask:0xf bank_mask:0x3
    v_mov_b32_dpp v108, v86 row_ror:8 row_mask:0xf bank_mask:0x3
    v_mov_b32_dpp v109, v87 row_ror:8 row_mask:0xf bank_mask:0x3
    buffer_store_dwordx4 v[96:99], v127, s[20:23], s69 offen offset:64 sc1
    s_add_u32 s3, s69, 32768
    buffer_store_dwordx4 v[106:109], v127, s[20:23], s3 offen offset:64 sc1
    buffer_load_dword v81, off, s[36:39], 0 sc1
    v_mfma_f32_16x16x32_bf16 v[180:183], v[72:75], v[44:47], v[180:183]
    s_waitcnt lgkmcnt(6)
    v_mfma_f32_16x16x32_bf16 v[188:191], v[76:79], v[44:47], v[188:191]
    ds_read_b64_tr_b16 v[72:73], v16 offset:32768
    v_mfma_f32_16x16x32_bf16 v[172:175], v[76:79], v[40:43], v[172:175]
    ds_read_b64_tr_b16 v[74:75], v16 offset:33792
    v_mfma_f32_16x16x32_bf16 v[156:159], v[76:79], v[36:39], v[156:159]
    ds_read_b128 v[56:59], v12 offset:36864
    buffer_load_dwordx4 v2, s[28:31], s93 offen offset:2048 lds
    v_mfma_f32_16x16x32_bf16 v[140:143], v[76:79], v[32:35], v[140:143]
    s_waitcnt lgkmcnt(7)
    v_mfma_f32_16x16x32_bf16 v[192:195], v[64:67], v[32:35], v[192:195]
    ds_read_b64_tr_b16 v[76:77], v16 offset:49152
    v_mfma_f32_16x16x32_bf16 v[208:211], v[64:67], v[36:39], v[208:211]
    ds_read_b64_tr_b16 v[78:79], v16 offset:50176
    v_mfma_f32_16x16x32_bf16 v[224:227], v[64:67], v[40:43], v[224:227]
    ds_read_b128 v[60:63], v12 offset:38912
    v_mfma_f32_16x16x32_bf16 v[240:243], v[64:67], v[44:47], v[240:243]
    s_waitcnt lgkmcnt(7)
    v_mfma_f32_16x16x32_bf16 v[248:251], v[68:71], v[44:47], v[248:251]
    ds_read_b64_tr_b16 v[64:65], v13 offset:40960
    buffer_load_dwordx4 v2, s[28:31], s93 offen offset:3072 lds
    s_add_u32 s93, s93, 4
    v_mfma_f32_16x16x32_bf16 v[232:235], v[68:71], v[40:43], v[232:235]
    ds_read_b64_tr_b16 v[66:67], v13 offset:41984
    v_mfma_f32_16x16x32_bf16 v[216:219], v[68:71], v[36:39], v[216:219]
    v_mfma_f32_16x16x32_bf16 v[200:203], v[68:71], v[32:35], v[200:203]
    s_waitcnt lgkmcnt(6)
    v_mfma_f32_16x16x32_bf16 v[196:199], v[72:75], v[32:35], v[196:199]
    ds_read_b64_tr_b16 v[68:69], v13 offset:57344
    v_mfma_f32_16x16x32_bf16 v[212:215], v[72:75], v[36:39], v[212:215]
    ds_read_b64_tr_b16 v[70:71], v13 offset:58368
    v_mfma_f32_16x16x32_bf16 v[228:231], v[72:75], v[40:43], v[228:231]
    s_add_u32 m0, s87, 4240
    s_nop 0
    buffer_load_dwordx4 v2, s[28:31], s93 offen offset:0 lds
    v_mfma_f32_16x16x32_bf16 v[244:247], v[72:75], v[44:47], v[244:247]
    s_waitcnt lgkmcnt(5)
    v_mfma_f32_16x16x32_bf16 v[252:255], v[76:79], v[44:47], v[252:255]
    ds_read_b64_tr_b16 v[72:73], v14 offset:40960
    v_mfma_f32_16x16x32_bf16 v[236:239], v[76:79], v[40:43], v[236:239]
    ds_read_b64_tr_b16 v[74:75], v14 offset:41984
    v_mfma_f32_16x16x32_bf16 v[220:223], v[76:79], v[36:39], v[220:223]
    v_mfma_f32_16x16x32_bf16 v[204:207], v[76:79], v[32:35], v[204:207]
    s_waitcnt lgkmcnt(4)
    v_mfma_f32_16x16x32_bf16 v[128:131], v[64:67], v[48:51], v[128:131]
    ds_read_b64_tr_b16 v[76:77], v14 offset:57344
    buffer_load_dwordx4 v2, s[28:31], s93 offen offset:1024 lds
    v_mfma_f32_16x16x32_bf16 v[144:147], v[64:67], v[52:55], v[144:147]
    ds_read_b64_tr_b16 v[78:79], v14 offset:58368
    v_mfma_f32_16x16x32_bf16 v[160:163], v[64:67], v[56:59], v[160:163]
    v_mfma_f32_16x16x32_bf16 v[176:179], v[64:67], v[60:63], v[176:179]
    s_waitcnt lgkmcnt(4)
    v_mfma_f32_16x16x32_bf16 v[184:187], v[68:71], v[60:63], v[184:187]
    ds_read_b64_tr_b16 v[64:65], v15 offset:40960
    v_mfma_f32_16x16x32_bf16 v[168:171], v[68:71], v[56:59], v[168:171]
    ds_read_b64_tr_b16 v[66:67], v15 offset:41984
    v_mfma_f32_16x16x32_bf16 v[152:155], v[68:71], v[52:55], v[152:155]
    buffer_load_dwordx4 v2, s[28:31], s93 offen offset:2048 lds
    v_mfma_f32_16x16x32_bf16 v[136:139], v[68:71], v[48:51], v[136:139]
    s_waitcnt lgkmcnt(4)
    v_mfma_f32_16x16x32_bf16 v[132:135], v[72:75], v[48:51], v[132:135]
    ds_read_b64_tr_b16 v[68:69], v15 offset:57344
    v_mfma_f32_16x16x32_bf16 v[148:151], v[72:75], v[52:55], v[148:151]
    ds_read_b64_tr_b16 v[70:71], v15 offset:58368
    v_mfma_f32_16x16x32_bf16 v[164:167], v[72:75], v[56:59], v[164:167]
    v_mfma_f32_16x16x32_bf16 v[180:183], v[72:75], v[60:63], v[180:183]
    s_waitcnt lgkmcnt(4)
    v_mfma_f32_16x16x32_bf16 v[188:191], v[76:79], v[60:63], v[188:191]
    ds_read_b64_tr_b16 v[72:73], v16 offset:40960
    buffer_load_dwordx4 v2, s[28:31], s93 offen offset:3072 lds
    v_mfma_f32_16x16x32_bf16 v[172:175], v[76:79], v[56:59], v[172:175]
    ds_read_b64_tr_b16 v[74:75], v16 offset:41984
    v_mfma_f32_16x16x32_bf16 v[156:159], v[76:79], v[52:55], v[156:159]
    v_mfma_f32_16x16x32_bf16 v[140:143], v[76:79], v[48:51], v[140:143]
    s_waitcnt lgkmcnt(4)
    v_mfma_f32_16x16x32_bf16 v[192:195], v[64:67], v[48:51], v[192:195]
    ds_read_b64_tr_b16 v[76:77], v16 offset:57344
    v_mfma_f32_16x16x32_bf16 v[208:211], v[64:67], v[52:55], v[208:211]
    ds_read_b64_tr_b16 v[78:79], v16 offset:58368
    v_mfma_f32_16x16x32_bf16 v[224:227], v[64:67], v[56:59], v[224:227]
    v_mfma_f32_16x16x32_bf16 v[240:243], v[64:67], v[60:63], v[240:243]
    s_waitcnt lgkmcnt(4)
    v_mfma_f32_16x16x32_bf16 v[248:251], v[68:71], v[60:63], v[248:251]
    v_mfma_f32_16x16x32_bf16 v[232:235], v[68:71], v[56:59], v[232:235]
    s_waitcnt vmcnt(12) lgkmcnt(0)
    s_barrier
    v_mfma_f32_16x16x32_bf16 v[216:219], v[68:71], v[52:55], v[216:219]
    ds_read_b128 v[32:35], v11 offset:0
    s_add_u32 m0, s101, 32768
    s_nop 0
    buffer_load_dwordx4 v21, s[16:19], s40 offen offset:0 lds
    v_mfma_f32_16x16x32_bf16 v[200:203], v[68:71], v[48:51], v[200:203]
    ds_read_b64_tr_b16 v[64:65], v13 offset:0
    v_mfma_f32_16x16x32_bf16 v[196:199], v[72:75], v[48:51], v[196:199]
    ds_read_b64_tr_b16 v[66:67], v13 offset:1024
    s_mov_b64 s[32:33], s[0:1]
    v_mfma_f32_16x16x32_bf16 v[212:215], v[72:75], v[52:55], v[212:215]
    ds_read_b128 v[36:39], v11 offset:2048
    s_movk_i32 s34, 4096
    v_mfma_f32_16x16x32_bf16 v[228:231], v[72:75], v[56:59], v[228:231]
    ds_read_b128 v[40:43], v11 offset:4096
    s_mul_i32 s75, s73, 9472
    v_mfma_f32_16x16x32_bf16 v[244:247], v[72:75], v[60:63], v[244:247]
    ds_read_b128 v[44:47], v11 offset:6144
    v_mfma_f32_16x16x32_bf16 v[252:255], v[76:79], v[60:63], v[252:255]
    ds_read_b64_tr_b16 v[68:69], v13 offset:16384
    s_add_u32 s75, s75, 20992
    v_mfma_f32_16x16x32_bf16 v[236:239], v[76:79], v[56:59], v[236:239]
    ds_read_b64_tr_b16 v[70:71], v13 offset:17408
    buffer_load_dwordx4 v22, s[16:19], s40 offen offset:1024 lds
    v_mfma_f32_16x16x32_bf16 v[220:223], v[76:79], v[52:55], v[220:223]
    ds_read_b64_tr_b16 v[72:73], v14 offset:0
    s_waitcnt vmcnt(8)
    v_cmp_gt_u32 vcc, 1, v81
    s_nop 0
    s_cmp_eq_u64 vcc, 0
    s_cbranch_scc1 L_ok0
    s_mov_b32 s3, 262144
L_poll0:
    s_sleep 2
    buffer_load_dword v81, off, s[36:39], 0 sc1
    s_waitcnt vmcnt(0)
    v_cmp_gt_u32 vcc, 1, v81
    s_nop 0
    s_cmp_eq_u64 vcc, 0
    s_cbranch_scc1 L_ok0
    s_sub_u32 s3, s3, 1
    s_cmp_lg_u32 s3, 0
    s_cbranch_scc1 L_poll0
L_ok0:
    v_mov_b32 v81, 1
    s_mov_b64 exec, 1
    buffer_atomic_add v81, off, s[20:23], s70 sc1
    s_mov_b64 exec, -1
    v_mfma_f32_16x16x32_bf16 v[204:207], v[76:79], v[48:51], v[204:207]
    ds_read_b64_tr_b16 v[74:75], v14 offset:1024
    s_waitcnt lgkmcnt(7)
    v_mfma_f32_16x16x32_bf16 v[128:131], v[64:67], v[32:35], v[128:131]
    ds_read_b64_tr_b16 v[76:77], v14 offset:16384
    s_lshl_b32 s97, s74, 11
    s_waitcnt lgkmcnt(7)
    v_mfma_f32_16x16x32_bf16 v[144:147], v[64:67], v[36:39], v[144:147]
    ds_read_b64_tr_b16 v[78:79], v14 offset:17408
    s_add_u32 s75, s75, s97
    s_waitcnt lgkmcnt(7)
    v_mfma_f32_16x16x32_bf16 v[160:163], v[64:67], v[40:43], v[160:163]
    v_add_u32 v6, s75, v2
    v_mov_b32 v94, 0
    s_waitcnt lgkmcnt(6)
    v_mfma_f32_16x16x32_bf16 v[176:179], v[64:67], v[44:47], v[176:179]
    v_mov_b32 v95, 0
    s_waitcnt lgkmcnt(4)
    v_mfma_f32_16x16x32_bf16 v[184:187], v[68:71], v[44:47], v[184:187]
    ds_read_b64_tr_b16 v[64:65], v15 offset:0
    buffer_load_dwordx4 v92, s[16:19], s40 offen offset:2048 lds
    v_mfma_f32_16x16x32_bf16 v[168:171], v[68:71], v[40:43], v[168:171]
    ds_read_b64_tr_b16 v[66:67], v15 offset:1024
    s_lshl_b32 s75, s68, 10
    v_mfma_f32_16x16x32_bf16 v[152:155], v[68:71], v[36:39], v[152:155]
    ds_read_b128 v[48:51], v12 offset:0
    v_add_u32 v9, s75, v2
    v_mfma_f32_16x16x32_bf16 v[136:139], v[68:71], v[32:35], v[136:139]
    v_xor_b32 v10, 1024, v9
    s_waitcnt lgkmcnt(5)
    v_mfma_f32_16x16x32_bf16 v[132:135], v[72:75], v[32:35], v[132:135]
    ds_read_b64_tr_b16 v[68:69], v15 offset:16384
    v_xor_b32 v7, 2048, v9
    v_mfma_f32_16x16x32_bf16 v[148:151], v[72:75], v[36:39], v[148:151]
    ds_read_b64_tr_b16 v[70:71], v15 offset:17408
    v_xor_b32 v3, 3072, v9
    v_mfma_f32_16x16x32_bf16 v[164:167], v[72:75], v[40:43], v[164:167]
    ds_read_b128 v[52:55], v12 offset:2048
    v_xor_b32 v28, 64, v23
    v_mfma_f32_16x16x32_bf16 v[180:183], v[72:75], v[44:47], v[180:183]
    buffer_load_dwordx4 v93, s[16:19], s40 offen offset:3072 lds
    s_waitcnt lgkmcnt(6)
    v_mfma_f32_16x16x32_bf16 v[188:191], v[76:79], v[44:47], v[188:191]
    ds_read_b64_tr_b16 v[72:73], v16 offset:0
    v_mov_b32 v4, v92
    v_mfma_f32_16x16x32_bf16 v[172:175], v[76:79], v[40:43], v[172:175]
    ds_read_b64_tr_b16 v[74:75], v16 offset:1024
    v_mov_b32 v5, v93
    v_mfma_f32_16x16x32_bf16 v[156:159], v[76:79], v[36:39], v[156:159]
    ds_read_b128 v[56:59], v12 offset:4096
    v_mfma_f32_16x16x32_bf16 v[140:143], v[76:79], v[32:35], v[140:143]
    s_waitcnt lgkmcnt(7)
    v_mfma_f32_16x16x32_bf16 v[192:195], v[64:67], v[32:35], v[192:195]
    ds_read_b64_tr_b16 v[76:77], v16 offset:16384
    v_mfma_f32_16x16x32_bf16 v[208:211], v[64:67], v[36:39], v[208:211]
    ds_read_b64_tr_b16 v[78:79], v16 offset:17408
    v_mfma_f32_16x16x32_bf16 v[224:227], v[64:67], v[40:43], v[224:227]
    ds_read_b128 v[60:63], v12 offset:6144
    s_add_u32 m0, s101, 36864
    s_nop 0
    buffer_load_dwordx4 v21, s[16:19], s41 offen offset:0 lds
    v_mfma_f32_16x16x32_bf16 v[240:243], v[64:67], v[44:47], v[240:243]
    s_waitcnt lgkmcnt(7)
    v_mfma_f32_16x16x32_bf16 v[248:251], v[68:71], v[44:47], v[248:251]
    ds_read_b64_tr_b16 v[64:65], v13 offset:8192
    v_mfma_f32_16x16x32_bf16 v[232:235], v[68:71], v[40:43], v[232:235]
    ds_read_b64_tr_b16 v[66:67], v13 offset:9216
    v_mfma_f32_16x16x32_bf16 v[216:219], v[68:71], v[36:39], v[216:219]
    v_mfma_f32_16x16x32_bf16 v[200:203], v[68:71], v[32:35], v[200:203]
    s_waitcnt lgkmcnt(6)
    v_mfma_f32_16x16x32_bf16 v[196:199], v[72:75], v[32:35], v[196:199]
    ds_read_b64_tr_b16 v[68:69], v13 offset:24576
    v_mfma_f32_16x16x32_bf16 v[212:215], v[72:75], v[36:39], v[212:215]
    ds_read_b64_tr_b16 v[70:71], v13 offset:25600
    buffer_load_dwordx4 v22, s[16:19], s41 offen offset:1024 lds
    v_mfma_f32_16x16x32_bf16 v[228:231], v[72:75], v[40:43], v[228:231]
    v_mfma_f32_16x16x32_bf16 v[244:247], v[72:75], v[44:47], v[244:247]
    s_waitcnt lgkmcnt(5)
    v_mfma_f32_16x16x32_bf16 v[252:255], v[76:79], v[44:47], v[252:255]
    ds_read_b64_tr_b16 v[72:73], v14 offset:8192
    v_mfma_f32_16x16x32_bf16 v[236:239], v[76:79], v[40:43], v[236:239]
    ds_read_b64_tr_b16 v[74:75], v14 offset:9216
    v_mfma_f32_16x16x32_bf16 v[220:223], v[76:79], v[36:39], v[220:223]
    v_mfma_f32_16x16x32_bf16 v[204:207], v[76:79], v[32:35], v[204:207]
    s_waitcnt lgkmcnt(4)
    v_mfma_f32_16x16x32_bf16 v[128:131], v[64:67], v[48:51], v[128:131]
    ds_read_b64_tr_b16 v[76:77], v14 offset:24576
    buffer_load_dwordx4 v4, s[16:19], s41 offen offset:2048 lds
    v_mfma_f32_16x16x32_bf16 v[144:147], v[64:67], v[52:55], v[144:147]
    ds_read_b64_tr_b16 v[78:79], v14 offset:25600
    v_mfma_f32_16x16x32_bf16 v[160:163], v[64:67], v[56:59], v[160:163]
    v_mfma_f32_16x16x32_bf16 v[176:179], v[64:67], v[60:63], v[176:179]
    s_waitcnt lgkmcnt(4)
    v_mfma_f32_16x16x32_bf16 v[184:187], v[68:71], v[60:63], v[184:187]
    ds_read_b64_tr_b16 v[64:65], v15 offset:8192
    v_mfma_f32_16x16x32_bf16 v[168:171], v[68:71], v[56:59], v[168:171]
    ds_read_b64_tr_b16 v[66:67], v15 offset:9216
    v_mfma_f32_16x16x32_bf16 v[152:155], v[68:71], v[52:55], v[152:155]
    v_mfma_f32_16x16x32_bf16 v[136:139], v[68:71], v[48:51], v[136:139]
    buffer_load_dwordx4 v5, s[16:19], s41 offen offset:3072 lds
    s_waitcnt lgkmcnt(4)
    v_mfma_f32_16x16x32_bf16 v[132:135], v[72:75], v[48:51], v[132:135]
    ds_read_b64_tr_b16 v[68:69], v15 offset:24576
    v_mfma_f32_16x16x32_bf16 v[148:151], v[72:75], v[52:55], v[148:151]
    ds_read_b64_tr_b16 v[70:71], v15 offset:25600
    v_mfma_f32_16x16x32_bf16 v[164:167], v[72:75], v[56:59], v[164:167]
    v_mfma_f32_16x16x32_bf16 v[180:183], v[72:75], v[60:63], v[180:183]
    s_waitcnt lgkmcnt(4)
    v_mfma_f32_16x16x32_bf16 v[188:191], v[76:79], v[60:63], v[188:191]
    ds_read_b64_tr_b16 v[72:73], v16 offset:8192
    v_mfma_f32_16x16x32_bf16 v[172:175], v[76:79], v[56:59], v[172:175]
    ds_read_b64_tr_b16 v[74:75], v16 offset:9216
    v_mfma_f32_16x16x32_bf16 v[156:159], v[76:79], v[52:55], v[156:159]
    v_mfma_f32_16x16x32_bf16 v[140:143], v[76:79], v[48:51], v[140:143]
    s_waitcnt lgkmcnt(4)
    v_mfma_f32_16x16x32_bf16 v[192:195], v[64:67], v[48:51], v[192:195]
    ds_read_b64_tr_b16 v[76:77], v16 offset:24576
    v_mfma_f32_16x16x32_bf16 v[208:211], v[64:67], v[52:55], v[208:211]
    ds_read_b64_tr_b16 v[78:79], v16 offset:25600
    v_mfma_f32_16x16x32_bf16 v[224:227], v[64:67], v[56:59], v[224:227]
    v_mfma_f32_16x16x32_bf16 v[240:243], v[64:67], v[60:63], v[240:243]
    s_waitcnt lgkmcnt(4)
    v_mfma_f32_16x16x32_bf16 v[248:251], v[68:71], v[60:63], v[248:251]
    v_mfma_f32_16x16x32_bf16 v[232:235], v[68:71], v[56:59], v[232:235]
    s_waitcnt lgkmcnt(0)
    s_barrier
    v_mfma_f32_16x16x32_bf16 v[216:219], v[68:71], v[52:55], v[216:219]
    s_add_u32 m0, s101, 0
    s_nop 0
    buffer_load_dwordx4 v21, s[16:19], s42 offen offset:0 lds
    v_mfma_f32_16x16x32_bf16 v[200:203], v[68:71], v[48:51], v[200:203]
    v_mfma_f32_16x16x32_bf16 v[196:199], v[72:75], v[48:51], v[196:199]
    buffer_load_dwordx4 v22, s[16:19], s42 offen offset:1024 lds
    v_mfma_f32_16x16x32_bf16 v[212:215], v[72:75], v[52:55], v[212:215]
    v_mfma_f32_16x16x32_bf16 v[228:231], v[72:75], v[56:59], v[228:231]
    buffer_load_dwordx4 v4, s[16:19], s42 offen offset:2048 lds
    v_mfma_f32_16x16x32_bf16 v[244:247], v[72:75], v[60:63], v[244:247]
    v_mfma_f32_16x16x32_bf16 v[252:255], v[76:79], v[60:63], v[252:255]
    buffer_load_dwordx4 v5, s[16:19], s42 offen offset:3072 lds
    v_mfma_f32_16x16x32_bf16 v[236:239], v[76:79], v[56:59], v[236:239]
    v_mfma_f32_16x16x32_bf16 v[220:223], v[76:79], v[52:55], v[220:223]
    s_add_u32 m0, s101, 4096
    s_nop 0
    buffer_load_dwordx4 v21, s[16:19], s43 offen offset:0 lds
    v_mfma_f32_16x16x32_bf16 v[204:207], v[76:79], v[48:51], v[204:207]
    buffer_load_dwordx4 v22, s[16:19], s43 offen offset:1024 lds
    buffer_load_dwordx4 v4, s[16:19], s43 offen offset:2048 lds
    buffer_load_dwordx4 v5, s[16:19], s43 offen offset:3072 lds
L_Bend:
    v_xor_b32 v16, 0x60, v23
    v_pk_mul_f32 v[84:85], v[128:129], s[88:89]
    v_pk_mul_f32 v[86:87], v[130:131], s[88:89]
    s_waitcnt vmcnt(15)
    ds_read_b64_tr_b16 a[0:1], v23 offset:32768
    v_pk_mul_f32 v[88:89], v[132:133], s[88:89]
    v_pk_mul_f32 v[90:91], v[134:135], s[88:89]
    ds_read_b64_tr_b16 a[4:5], v24 offset:32768
    v_exp_f32 v84, v84
    v_exp_f32 v85, v85
    ds_read_b64_tr_b16 a[8:9], v28 offset:32768
    v_exp_f32 v86, v86
    v_exp_f32 v87, v87
    ds_read_b64_tr_b16 a[12:13], v16 offset:32768
    v_exp_f32 v88, v88
    v_exp_f32 v89, v89
    ds_write_b32 v82, v80
    v_exp_f32 v90, v90
    v_exp_f32 v91, v91
    ds_write_b64 v83, v[94:95] offset:4096
    v_pk_mul_f32 v[128:129], v[128:129], v[136:137]
    v_pk_mul_f32 v[130:131], v[130:131], v[138:139]
    v_pk_mul_f32 v[132:133], v[132:133], v[140:141]
    v_pk_mul_f32 v[134:135], v[134:135], v[142:143]
    v_pk_add_f32 v[84:85], v[84:85], 1.0 op_sel_hi:[1,0]
    v_pk_add_f32 v[86:87], v[86:87], 1.0 op_sel_hi:[1,0]
    v_pk_add_f32 v[88:89], v[88:89], 1.0 op_sel_hi:[1,0]
    v_pk_add_f32 v[90:91], v[90:91], 1.0 op_sel_hi:[1,0]
    v_rcp_f32 v84, v84
    v_rcp_f32 v85, v85
    v_rcp_f32 v86, v86
    v_rcp_f32 v87, v87
    v_rcp_f32 v88, v88
    v_rcp_f32 v89, v89
    v_rcp_f32 v90, v90
    v_rcp_f32 v91, v91
    v_pk_mul_f32 v[128:129], v[128:129], v[84:85]
    v_pk_mul_f32 v[130:131], v[130:131], v[86:87]
    v_pk_mul_f32 v[132:133], v[132:133], v[88:89]
    v_pk_mul_f32 v[134:135], v[134:135], v[90:91]
    v_cvt_pk_bf16_f32 v32, v128, v129
    v_cvt_pk_bf16_f32 v33, v130, v131
    v_cvt_pk_bf16_f32 v34, v132, v133
    v_cvt_pk_bf16_f32 v35, v134, v135
    v_pk_mul_f32 v[84:85], v[144:145], s[88:89]
    v_pk_mul_f32 v[86:87], v[146:147], s[88:89]
    v_mov_b32 v81, 32
    s_mov_b64 exec, 1
    v_mov_b32 v81, 0
    buffer_atomic_add v81, off, s[20:23], s99 sc0 sc1
    s_mov_b64 exec, -1
    v_pk_mul_f32 v[88:89], v[148:149], s[88:89]
    v_pk_mul_f32 v[90:91], v[150:151], s[88:89]
    s_waitcnt vmcnt(13)
    ds_read_b64_tr_b16 a[2:3], v23 offset:34816
    v_exp_f32 v84, v84
    v_exp_f32 v85, v85
    ds_read_b64_tr_b16 a[6:7], v24 offset:34816
    v_exp_f32 v86, v86
    v_exp_f32 v87, v87
    ds_read_b64_tr_b16 a[10:11], v28 offset:34816
    v_exp_f32 v88, v88
    v_exp_f32 v89, v89
    ds_read_b64_tr_b16 a[14:15], v16 offset:34816
    v_exp_f32 v90, v90
    v_exp_f32 v91, v91
    s_waitcnt lgkmcnt(6)
    s_add_u32 m0, s101, 32768
    s_nop 0
    buffer_load_dwordx4 v21, s[16:19], s44 offen offset:0 lds
    v_pk_mul_f32 v[144:145], v[144:145], v[152:153]
    v_pk_mul_f32 v[146:147], v[146:147], v[154:155]
    buffer_load_dwordx4 v22, s[16:19], s44 offen offset:1024 lds
    v_pk_mul_f32 v[148:149], v[148:149], v[156:157]
    v_pk_mul_f32 v[150:151], v[150:151], v[158:159]
    v_pk_add_f32 v[84:85], v[84:85], 1.0 op_sel_hi:[1,0]
    v_pk_add_f32 v[86:87], v[86:87], 1.0 op_sel_hi:[1,0]
    v_pk_add_f32 v[88:89], v[88:89], 1.0 op_sel_hi:[1,0]
    v_pk_add_f32 v[90:91], v[90:91], 1.0 op_sel_hi:[1,0]
    v_rcp_f32 v84, v84
    v_rcp_f32 v85, v85
    v_rcp_f32 v86, v86
    v_rcp_f32 v87, v87
    v_rcp_f32 v88, v88
    v_rcp_f32 v89, v89
    v_rcp_f32 v90, v90
    v_rcp_f32 v91, v91
    v_pk_mul_f32 v[144:145], v[144:145], v[84:85]
    v_pk_mul_f32 v[146:147], v[146:147], v[86:87]
    v_pk_mul_f32 v[148:149], v[148:149], v[88:89]
    v_pk_mul_f32 v[150:151], v[150:151], v[90:91]
    v_cvt_pk_bf16_f32 v36, v144, v145
    v_cvt_pk_bf16_f32 v37, v146, v147
    v_cvt_pk_bf16_f32 v38, v148, v149
    v_cvt_pk_bf16_f32 v39, v150, v151
    buffer_store_dwordx4 v[32:35], v2, s[20:23], s94 offen offset:0 sc1
    v_pk_mul_f32 v[84:85], v[160:161], s[88:89]
    v_pk_mul_f32 v[86:87], v[162:163], s[88:89]
    s_waitcnt vmcnt(14)
    ds_read_b64_tr_b16 a[16:17], v23 offset:36864
    v_pk_mul_f32 v[88:89], v[164:165], s[88:89]
    v_pk_mul_f32 v[90:91], v[166:167], s[88:89]
    ds_read_b64_tr_b16 a[20:21], v24 offset:36864
    v_exp_f32 v84, v84
    v_exp_f32 v85, v85
    ds_read_b64_tr_b16 a[24:25], v28 offset:36864
    v_exp_f32 v86, v86
    v_exp_f32 v87, v87
    ds_read_b64_tr_b16 a[28:29], v16 offset:36864
    v_exp_f32 v88, v88
    v_exp_f32 v89, v89
    s_waitcnt lgkmcnt(4)
    buffer_load_dwordx4 v4, s[16:19], s44 offen offset:2048 lds
    v_exp_f32 v90, v90
    v_exp_f32 v91, v91
    buffer_load_dwordx4 v5, s[16:19], s44 offen offset:3072 lds
    v_pk_mul_f32 v[160:161], v[160:161], v[168:169]
    v_pk_mul_f32 v[162:163], v[162:163], v[170:171]
    v_pk_mul_f32 v[164:165], v[164:165], v[172:173]
    v_pk_mul_f32 v[166:167], v[166:167], v[174:175]
    v_pk_add_f32 v[84:85], v[84:85], 1.0 op_sel_hi:[1,0]
    v_pk_add_f32 v[86:87], v[86:87], 1.0 op_sel_hi:[1,0]
    v_pk_add_f32 v[88:89], v[88:89], 1.0 op_sel_hi:[1,0]
    v_pk_add_f32 v[90:91], v[90:91], 1.0 op_sel_hi:[1,0]
    v_rcp_f32 v84, v84
    v_rcp_f32 v85, v85
    v_rcp_f32 v86, v86
    v_rcp_f32 v87, v87
    v_rcp_f32 v88, v88
    v_rcp_f32 v89, v89
    v_rcp_f32 v90, v90
    v_rcp_f32 v91, v91
    v_pk_mul_f32 v[160:161], v[160:161], v[84:85]
    v_pk_mul_f32 v[162:163], v[162:163], v[86:87]
    v_pk_mul_f32 v[164:165], v[164:165], v[88:89]
    v_pk_mul_f32 v[166:167], v[166:167], v[90:91]
    v_cvt_pk_bf16_f32 v40, v160, v161
    v_cvt_pk_bf16_f32 v41, v162, v163
    v_cvt_pk_bf16_f32 v42, v164, v165
    v_cvt_pk_bf16_f32 v43, v166, v167
    buffer_store_dwordx4 v[36:39], v2, s[20:23], s94 offen offset:1024 sc1
    v_pk_mul_f32 v[84:85], v[176:177], s[88:89]
    v_pk_mul_f32 v[86:87], v[178:179], s[88:89]
    s_waitcnt vmcnt(15)
    ds_read_b64_tr_b16 a[18:19], v23 offset:38912
    v_pk_mul_f32 v[88:89], v[180:181], s[88:89]
    v_pk_mul_f32 v[90:91], v[182:183], s[88:89]
    ds_read_b64_tr_b16 a[22:23], v24 offset:38912
    v_exp_f32 v84, v84
    v_exp_f32 v85, v85
    ds_read_b64_tr_b16 a[26:27], v28 offset:38912
    v_exp_f32 v86, v86
    v_exp_f32 v87, v87
    ds_read_b64_tr_b16 a[30:31], v16 offset:38912
    v_exp_f32 v88, v88
    v_exp_f32 v89, v89
    s_waitcnt lgkmcnt(4)
    s_add_u32 m0, s101, 36864
    s_nop 0
    buffer_load_dwordx4 v21, s[16:19], s45 offen offset:0 lds
    v_exp_f32 v90, v90
    v_exp_f32 v91, v91
    buffer_load_dwordx4 v22, s[16:19], s45 offen offset:1024 lds
    v_pk_mul_f32 v[176:177], v[176:177], v[184:185]
    v_pk_mul_f32 v[178:179], v[178:179], v[186:187]
    v_pk_mul_f32 v[180:181], v[180:181], v[188:189]
    v_pk_mul_f32 v[182:183], v[182:183], v[190:191]
    v_pk_add_f32 v[84:85], v[84:85], 1.0 op_sel_hi:[1,0]
    v_pk_add_f32 v[86:87], v[86:87], 1.0 op_sel_hi:[1,0]
    v_pk_add_f32 v[88:89], v[88:89], 1.0 op_sel_hi:[1,0]
    v_pk_add_f32 v[90:91], v[90:91], 1.0 op_sel_hi:[1,0]
    v_rcp_f32 v84, v84
    v_rcp_f32 v85, v85
    v_rcp_f32 v86, v86
    v_rcp_f32 v87, v87
    v_rcp_f32 v88, v88
    v_rcp_f32 v89, v89
    v_rcp_f32 v90, v90
    v_rcp_f32 v91, v91
    v_pk_mul_f32 v[176:177], v[176:177], v[84:85]
    v_pk_mul_f32 v[178:179], v[178:179], v[86:87]
    v_pk_mul_f32 v[180:181], v[180:181], v[88:89]
    v_pk_mul_f32 v[182:183], v[182:183], v[90:91]
    v_cvt_pk_bf16_f32 v44, v176, v177
    v_cvt_pk_bf16_f32 v45, v178, v179
    v_cvt_pk_bf16_f32 v46, v180, v181
    v_cvt_pk_bf16_f32 v47, v182, v183
    buffer_store_dwordx4 v[40:43], v2, s[20:23], s94 offen offset:2048 sc1
    v_pk_mul_f32 v[84:85], v[192:193], s[88:89]
    v_pk_mul_f32 v[86:87], v[194:195], s[88:89]
    s_waitcnt vmcnt(9)
    v_cmp_gt_u32 vcc, 32, v81
    s_nop 0
    s_cmp_eq_u64 vcc, 0
    s_cbranch_scc1 L_ok1
    s_mov_b32 s3, 262144
L_poll1:
    s_sleep 2
    v_mov_b32 v81, 32
    s_mov_b64 exec, 1
    v_mov_b32 v81, 0
    buffer_atomic_add v81, off, s[20:23], s99 sc0 sc1
    s_mov_b64 exec, -1
    s_waitcnt vmcnt(0)
    v_cmp_gt_u32 vcc, 32, v81
    s_nop 0
    s_cmp_eq_u64 vcc, 0
    s_cbranch_scc1 L_ok1
    s_sub_u32 s3, s3, 1
    s_cmp_lg_u32 s3, 0
    s_cbranch_scc1 L_poll1
L_ok1:
    buffer_load_dwordx4 v[96:99], v2, s[32:35], s97 offen offset:0 sc1
    buffer_load_dword v100, v2, s[32:35], s97 offen offset:16 sc1
    buffer_load_dwordx4 v[104:107], v2, s[32:35], s97 offen offset:1024 sc1
    buffer_load_dword v108, v2, s[32:35], s97 offen offset:1040 sc1
    v_pk_mul_f32 v[88:89], v[196:197], s[88:89]
    v_pk_mul_f32 v[90:91], v[198:199], s[88:89]
    ds_read_b64_tr_b16 a[32:33], v23 offset:0
    v_exp_f32 v84, v84
    v_exp_f32 v85, v85
    ds_read_b64_tr_b16 a[36:37], v24 offset:0
    v_exp_f32 v86, v86
    v_exp_f32 v87, v87
    ds_read_b64_tr_b16 a[40:41], v28 offset:0
    v_exp_f32 v88, v88
    v_exp_f32 v89, v89
    ds_read_b64_tr_b16 a[44:45], v16 offset:0
    v_exp_f32 v90, v90
    v_exp_f32 v91, v91
    s_waitcnt lgkmcnt(4)
    buffer_load_dwordx4 v4, s[16:19], s45 offen offset:2048 lds
    v_pk_mul_f32 v[192:193], v[192:193], v[200:201]
    v_pk_mul_f32 v[194:195], v[194:195], v[202:203]
    buffer_load_dwordx4 v5, s[16:19], s45 offen offset:3072 lds
    v_pk_mul_f32 v[196:197], v[196:197], v[204:205]
    v_pk_mul_f32 v[198:199], v[198:199], v[206:207]
    v_pk_add_f32 v[84:85], v[84:85], 1.0 op_sel_hi:[1,0]
    v_pk_add_f32 v[86:87], v[86:87], 1.0 op_sel_hi:[1,0]
    v_pk_add_f32 v[88:89], v[88:89], 1.0 op_sel_hi:[1,0]
    v_pk_add_f32 v[90:91], v[90:91], 1.0 op_sel_hi:[1,0]
    v_rcp_f32 v84, v84
    v_rcp_f32 v85, v85
    v_rcp_f32 v86, v86
    v_rcp_f32 v87, v87
    v_rcp_f32 v88, v88
    v_rcp_f32 v89, v89
    v_rcp_f32 v90, v90
    v_rcp_f32 v91, v91
    v_pk_mul_f32 v[192:193], v[192:193], v[84:85]
    v_pk_mul_f32 v[194:195], v[194:195], v[86:87]
    v_pk_mul_f32 v[196:197], v[196:197], v[88:89]
    v_pk_mul_f32 v[198:199], v[198:199], v[90:91]
    v_cvt_pk_bf16_f32 v48, v192, v193
    v_cvt_pk_bf16_f32 v49, v194, v195
    v_cvt_pk_bf16_f32 v50, v196, v197
    v_cvt_pk_bf16_f32 v51, v198, v199
    v_pk_mul_f32 v[84:85], v[208:209], s[88:89]
    v_pk_mul_f32 v[86:87], v[210:211], s[88:89]
    ds_read_b64_tr_b16 a[34:35], v23 offset:2048
    v_pk_mul_f32 v[88:89], v[212:213], s[88:89]
    v_pk_mul_f32 v[90:91], v[214:215], s[88:89]
    ds_read_b64_tr_b16 a[38:39], v24 offset:2048
    v_exp_f32 v84, v84
    v_exp_f32 v85, v85
    ds_read_b64_tr_b16 a[42:43], v28 offset:2048
    v_exp_f32 v86, v86
    v_exp_f32 v87, v87
    ds_read_b64_tr_b16 a[46:47], v16 offset:2048
    v_exp_f32 v88, v88
    v_exp_f32 v89, v89
    s_waitcnt lgkmcnt(4)
    s_add_u32 m0, s101, 0
    s_nop 0
    buffer_load_dwordx4 v21, s[16:19], s46 offen offset:0 lds
    v_exp_f32 v90, v90
    v_exp_f32 v91, v91
    buffer_load_dwordx4 v22, s[16:19], s46 offen offset:1024 lds
    v_pk_mul_f32 v[208:209], v[208:209], v[216:217]
    v_pk_mul_f32 v[210:211], v[210:211], v[218:219]
    v_pk_mul_f32 v[212:213], v[212:213], v[220:221]
    v_pk_mul_f32 v[214:215], v[214:215], v[222:223]
    v_pk_add_f32 v[84:85], v[84:85], 1.0 op_sel_hi:[1,0]
    v_pk_add_f32 v[86:87], v[86:87], 1.0 op_sel_hi:[1,0]
    v_pk_add_f32 v[88:89], v[88:89], 1.0 op_sel_hi:[1,0]
    v_pk_add_f32 v[90:91], v[90:91], 1.0 op_sel_hi:[1,0]
    v_rcp_f32 v84, v84
    v_rcp_f32 v85, v85
    v_rcp_f32 v86, v86
    v_rcp_f32 v87, v87
    v_rcp_f32 v88, v88
    v_rcp_f32 v89, v89
    v_rcp_f32 v90, v90
    v_rcp_f32 v91, v91
    v_pk_mul_f32 v[208:209], v[208:209], v[84:85]
    v_pk_mul_f32 v[210:211], v[210:211], v[86:87]
    v_pk_mul_f32 v[212:213], v[212:213], v[88:89]
    v_pk_mul_f32 v[214:215], v[214:215], v[90:91]
    v_cvt_pk_bf16_f32 v52, v208, v209
    v_cvt_pk_bf16_f32 v53, v210, v211
    v_cvt_pk_bf16_f32 v54, v212, v213
    v_cvt_pk_bf16_f32 v55, v214, v215
    buffer_store_dwordx4 v[44:47], v2, s[20:23], s94 offen offset:3072 sc1
    v_pk_mul_f32 v[84:85], v[224:225], s[88:89]
    v_pk_mul_f32 v[86:87], v[226:227], s[88:89]
    ds_read_b64_tr_b16 a[48:49], v23 offset:4096
    v_pk_mul_f32 v[88:89], v[228:229], s[88:89]
    v_pk_mul_f32 v[90:91], v[230:231], s[88:89]
    ds_read_b64_tr_b16 a[52:53], v24 offset:4096
    v_exp_f32 v84, v84
    v_exp_f32 v85, v85
    ds_read_b64_tr_b16 a[56:57], v28 offset:4096
    v_exp_f32 v86, v86
    v_exp_f32 v87, v87
    ds_read_b64_tr_b16 a[60:61], v16 offset:4096
    v_exp_f32 v88, v88
    v_exp_f32 v89, v89
    s_waitcnt lgkmcnt(4)
    buffer_load_dwordx4 v4, s[16:19], s46 offen offset:2048 lds
    v_exp_f32 v90, v90
    v_exp_f32 v91, v91
    buffer_load_dwordx4 v5, s[16:19], s46 offen offset:3072 lds
    v_pk_mul_f32 v[224:225], v[224:225], v[232:233]
    v_pk_mul_f32 v[226:227], v[226:227], v[234:235]
    v_pk_mul_f32 v[228:229], v[228:229], v[236:237]
    v_pk_mul_f32 v[230:231], v[230:231], v[238:239]
    v_pk_add_f32 v[84:85], v[84:85], 1.0 op_sel_hi:[1,0]
    v_pk_add_f32 v[86:87], v[86:87], 1.0 op_sel_hi:[1,0]
    v_pk_add_f32 v[88:89], v[88:89], 1.0 op_sel_hi:[1,0]
    v_pk_add_f32 v[90:91], v[90:91], 1.0 op_sel_hi:[1,0]
    v_rcp_f32 v84, v84
    v_rcp_f32 v85, v85
    v_rcp_f32 v86, v86
    v_rcp_f32 v87, v87
    v_rcp_f32 v88, v88
    v_rcp_f32 v89, v89
    v_rcp_f32 v90, v90
    v_rcp_f32 v91, v91
    v_pk_mul_f32 v[224:225], v[224:225], v[84:85]
    v_pk_mul_f32 v[226:227], v[226:227], v[86:87]
    v_pk_mul_f32 v[228:229], v[228:229], v[88:89]
    v_pk_mul_f32 v[230:231], v[230:231], v[90:91]
    v_cvt_pk_bf16_f32 v116, v224, v225
    v_cvt_pk_bf16_f32 v117, v226, v227
    v_cvt_pk_bf16_f32 v118, v228, v229
    v_cvt_pk_bf16_f32 v119, v230, v231
    buffer_store_dwordx4 v[48:51], v2, s[20:23], s98 offen offset:0 sc1
    v_pk_mul_f32 v[84:85], v[240:241], s[88:89]
    v_pk_mul_f32 v[86:87], v[242:243], s[88:89]
    ds_read_b64_tr_b16 a[50:51], v23 offset:6144
    v_pk_mul_f32 v[88:89], v[244:245], s[88:89]
    v_pk_mul_f32 v[90:91], v[246:247], s[88:89]
    ds_read_b64_tr_b16 a[54:55], v24 offset:6144
    v_exp_f32 v84, v84
    v_exp_f32 v85, v85
    ds_read_b64_tr_b16 a[58:59], v28 offset:6144
    v_exp_f32 v86, v86
    v_exp_f32 v87, v87
    ds_read_b64_tr_b16 a[62:63], v16 offset:6144
    v_exp_f32 v88, v88
    v_exp_f32 v89, v89
    s_waitcnt lgkmcnt(4)
    s_add_u32 m0, s101, 4096
    s_nop 0
    buffer_load_dwordx4 v21, s[16:19], s47 offen offset:0 lds
    v_exp_f32 v90, v90
    v_exp_f32 v91, v91
    buffer_load_dwordx4 v22, s[16:19], s47 offen offset:1024 lds
    v_pk_mul_f32 v[240:241], v[240:241], v[248:249]
    v_pk_mul_f32 v[242:243], v[242:243], v[250:251]
    s_waitcnt vmcnt(12)
    v_alignbit_b32 v112, v97, v96, 16
    v_alignbit_b32 v113, v98, v97, 16
    v_alignbit_b32 v114, v99, v98, 16
    v_alignbit_b32 v115, v100, v99, 16
    ds_write_b128 v6, v[96:99] offset:0
    ds_write_b128 v6, v[112:115] offset:4640
    v_pk_mul_f32 v[244:245], v[244:245], v[252:253]
    v_pk_mul_f32 v[246:247], v[246:247], v[254:255]
    v_pk_add_f32 v[84:85], v[84:85], 1.0 op_sel_hi:[1,0]
    v_pk_add_f32 v[86:87], v[86:87], 1.0 op_sel_hi:[1,0]
    v_pk_add_f32 v[88:89], v[88:89], 1.0 op_sel_hi:[1,0]
    v_pk_add_f32 v[90:91], v[90:91], 1.0 op_sel_hi:[1,0]
    v_rcp_f32 v84, v84
    v_rcp_f32 v85, v85
    v_rcp_f32 v86, v86
    v_rcp_f32 v87, v87
    v_rcp_f32 v88, v88
    v_rcp_f32 v89, v89
    v_rcp_f32 v90, v90
    v_rcp_f32 v91, v91
    v_pk_mul_f32 v[240:241], v[240:241], v[84:85]
    v_pk_mul_f32 v[242:243], v[242:243], v[86:87]
    v_pk_mul_f32 v[244:245], v[244:245], v[88:89]
    v_pk_mul_f32 v[246:247], v[246:247], v[90:91]
    v_cvt_pk_bf16_f32 v120, v240, v241
    v_cvt_pk_bf16_f32 v121, v242, v243
    v_cvt_pk_bf16_f32 v122, v244, v245
    v_cvt_pk_bf16_f32 v123, v246, v247
    buffer_store_dwordx4 v[52:55], v2, s[20:23], s98 offen offset:1024 sc1
    s_waitcnt vmcnt(11)
    v_alignbit_b32 v112, v105, v104, 16
    v_alignbit_b32 v113, v106, v105, 16
    v_alignbit_b32 v114, v107, v106, 16
    v_alignbit_b32 v115, v108, v107, 16
    ds_write_b128 v6, v[104:107] offset:1024
    ds_write_b128 v6, v[112:115] offset:5664
    s_waitcnt lgkmcnt(0)
    s_barrier
    ds_read_b128 v[160:163], v25 offset:3584
    ds_read_b128 v[164:167], v25 offset:3072
    ds_read_b128 v[168:171], v25 offset:2560
    ds_read_b128 v[172:175], v25 offset:2048
    ds_read_b128 v[176:179], v25 offset:1536
    ds_read_b128 v[180:183], v25 offset:1024
    ds_read_b128 v[184:187], v25 offset:512
    ds_read_b128 v[188:191], v25 offset:0
    ds_read_b128 v[56:59], v26 offset:0
    ds_read_b128 v[60:63], v26 offset:512
    ds_read_b128 v[64:67], v26 offset:1024
    ds_read_b128 v[68:71], v26 offset:1536
    ds_read_b128 v[72:75], v26 offset:2048
    s_waitcnt lgkmcnt(12)
    v_mfma_f32_16x16x32_bf16 v[128:131], v[160:163], a[224:227], 0
    s_waitcnt lgkmcnt(11)
    v_mfma_f32_16x16x32_bf16 v[132:135], v[164:167], a[224:227], 0
    buffer_store_dwordx4 v[116:119], v2, s[20:23], s98 offen offset:2048 sc1
    s_waitcnt lgkmcnt(10)
    v_mfma_f32_16x16x32_bf16 v[136:139], v[168:171], a[224:227], 0
    s_waitcnt lgkmcnt(9)
    v_mfma_f32_16x16x32_bf16 v[140:143], v[172:175], a[224:227], 0
    s_waitcnt lgkmcnt(8)
    v_mfma_f32_16x16x32_bf16 v[144:147], v[176:179], a[224:227], 0
    s_waitcnt lgkmcnt(7)
    v_mfma_f32_16x16x32_bf16 v[148:151], v[180:183], a[224:227], 0
    s_waitcnt lgkmcnt(6)
    v_mfma_f32_16x16x32_bf16 v[152:155], v[184:187], a[224:227], 0
    s_waitcnt lgkmcnt(5)
    v_mfma_f32_16x16x32_bf16 v[156:159], v[188:191], a[224:227], 0
    s_waitcnt lgkmcnt(4)
    v_mfma_f32_16x16x32_bf16 v[128:131], v[160:163], v[56:59], v[128:131]
    ds_read_b128 v[76:79], v26 offset:2560
    v_mfma_f32_16x16x32_bf16 v[132:135], v[164:167], v[56:59], v[132:135]
    ds_read_b128 v[192:195], v25 offset:3648
    v_mfma_f32_16x16x32_bf16 v[136:139], v[168:171], v[56:59], v[136:139]
    ds_read_b128 v[196:199], v25 offset:3136
    v_mfma_f32_16x16x32_bf16 v[140:143], v[172:175], v[56:59], v[140:143]
    buffer_store_dwordx4 v[120:123], v2, s[20:23], s98 offen offset:3072 sc1
    v_mfma_f32_16x16x32_bf16 v[144:147], v[176:179], v[56:59], v[144:147]
    ds_read_b64_tr_b16 a[64:65], v23 offset:32768
    v_mfma_f32_16x16x32_bf16 v[148:151], v[180:183], v[56:59], v[148:151]
    ds_read_b64_tr_b16 a[68:69], v24 offset:32768
    v_mfma_f32_16x16x32_bf16 v[152:155], v[184:187], v[56:59], v[152:155]
    ds_read_b64_tr_b16 a[72:73], v28 offset:32768
    v_mfma_f32_16x16x32_bf16 v[156:159], v[188:191], v[56:59], v[156:159]
    ds_read_b64_tr_b16 a[76:77], v16 offset:32768
    s_waitcnt lgkmcnt(10)
    v_mfma_f32_16x16x32_bf16 v[132:135], v[160:163], v[60:63], v[132:135]
    ds_read_b128 v[56:59], v26 offset:3072
    v_mfma_f32_16x16x32_bf16 v[136:139], v[164:167], v[60:63], v[136:139]
    ds_read_b128 v[200:203], v25 offset:2624
    v_mfma_f32_16x16x32_bf16 v[140:143], v[168:171], v[60:63], v[140:143]
    ds_read_b128 v[204:207], v25 offset:2112
    v_mfma_f32_16x16x32_bf16 v[144:147], v[172:175], v[60:63], v[144:147]
    buffer_load_dwordx4 v4, s[16:19], s47 offen offset:2048 lds
    v_mfma_f32_16x16x32_bf16 v[148:151], v[176:179], v[60:63], v[148:151]
    buffer_load_dwordx4 v5, s[16:19], s47 offen offset:3072 lds
    v_mfma_f32_16x16x32_bf16 v[152:155], v[180:183], v[60:63], v[152:155]
    ds_read_b64_tr_b16 a[66:67], v23 offset:34816
    v_mfma_f32_16x16x32_bf16 v[156:159], v[184:187], v[60:63], v[156:159]
    ds_read_b64_tr_b16 a[70:71], v24 offset:34816
    s_waitcnt lgkmcnt(14)
    v_mfma_f32_16x16x32_bf16 v[136:139], v[160:163], v[64:67], v[136:139]
    ds_read_b128 v[60:63], v26 offset:3584
    v_mfma_f32_16x16x32_bf16 v[140:143], v[164:167], v[64:67], v[140:143]
    ds_read_b128 v[208:211], v25 offset:1600
    v_mfma_f32_16x16x32_bf16 v[144:147], v[168:171], v[64:67], v[144:147]
    ds_read_b128 v[212:215], v25 offset:1088
    v_mfma_f32_16x16x32_bf16 v[148:151], v[172:175], v[64:67], v[148:151]
    ds_read_b64_tr_b16 a[74:75], v28 offset:34816
    v_mfma_f32_16x16x32_bf16 v[152:155], v[176:179], v[64:67], v[152:155]
    ds_read_b64_tr_b16 a[78:79], v16 offset:34816
    v_mfma_f32_16x16x32_bf16 v[156:159], v[180:183], v[64:67], v[156:159]
    s_waitcnt lgkmcnt(10)
    s_add_u32 m0, s101, 32768
    s_nop 0
    buffer_load_dwordx4 v21, s[16:19], s48 offen offset:0 lds
    v_mfma_f32_16x16x32_bf16 v[140:143], v[160:163], v[68:71], v[140:143]
    ds_read_b128 v[64:67], v26 offset:64
    v_mfma_f32_16x16x32_bf16 v[144:147], v[164:167], v[68:71], v[144:147]
    ds_read_b128 v[216:219], v25 offset:576
    v_mfma_f32_16x16x32_bf16 v[148:151], v[168:171], v[68:71], v[148:151]
    ds_read_b128 v[220:223], v25 offset:64
    v_mfma_f32_16x16x32_bf16 v[152:155], v[172:175], v[68:71], v[152:155]
    buffer_load_dwordx4 v22, s[16:19], s48 offen offset:1024 lds
    v_mfma_f32_16x16x32_bf16 v[156:159], v[176:179], v[68:71], v[156:159]
    ds_read_b64_tr_b16 a[80:81], v23 offset:36864
    v_mfma_f32_16x16x32_bf16 v[144:147], v[160:163], v[72:75], v[144:147]
    ds_read_b128 v[68:71], v26 offset:576
    v_mfma_f32_16x16x32_bf16 v[148:151], v[164:167], v[72:75], v[148:151]
    ds_read_b64_tr_b16 a[84:85], v24 offset:36864
    v_mfma_f32_16x16x32_bf16 v[152:155], v[168:171], v[72:75], v[152:155]
    ds_read_b64_tr_b16 a[88:89], v28 offset:36864
    v_mfma_f32_16x16x32_bf16 v[156:159], v[172:175], v[72:75], v[156:159]
    ds_read_b64_tr_b16 a[92:93], v16 offset:36864
    v_mfma_f32_16x16x32_bf16 v[148:151], v[160:163], v[76:79], v[148:151]
    ds_read_b128 v[72:75], v26 offset:1088
    v_mfma_f32_16x16x32_bf16 v[152:155], v[164:167], v[76:79], v[152:155]
    s_waitcnt lgkmcnt(9)
    buffer_load_dwordx4 v4, s[16:19], s48 offen offset:2048 lds
    v_mfma_f32_16x16x32_bf16 v[156:159], v[168:171], v[76:79], v[156:159]
    buffer_load_dwordx4 v5, s[16:19], s48 offen offset:3072 lds
    v_mfma_f32_16x16x32_bf16 v[152:155], v[160:163], v[56:59], v[152:155]
    ds_read_b128 v[76:79], v26 offset:1600
    v_mfma_f32_16x16x32_bf16 v[156:159], v[164:167], v[56:59], v[156:159]
    s_waitcnt vmcnt(17)
    ds_read_b64_tr_b16 a[82:83], v23 offset:38912
    v_mfma_f32_16x16x32_bf16 v[156:159], v[160:163], v[60:63], v[156:159]
    ds_read_b128 v[56:59], v26 offset:2112
    s_waitcnt lgkmcnt(11)
    v_mfma_f32_16x16x32_bf16 v[128:131], v[192:195], v[64:67], v[128:131]
    ds_read_b128 v[60:63], v26 offset:2624
    v_mfma_f32_16x16x32_bf16 v[132:135], v[196:199], v[64:67], v[132:135]
    ds_read_b128 v[160:163], v25 offset:3712
    v_mfma_f32_16x16x32_bf16 v[136:139], v[200:203], v[64:67], v[136:139]
    ds_read_b128 v[164:167], v25 offset:3200
    v_mfma_f32_16x16x32_bf16 v[140:143], v[204:207], v[64:67], v[140:143]
    s_waitcnt vmcnt(6)
    v_mov_b32 v29, 1
    s_mov_b64 exec, 1
    buffer_atomic_add v29, off, s[20:23], s91 sc1
    s_mov_b64 exec, -1
    v_mfma_f32_16x16x32_bf16 v[144:147], v[208:211], v[64:67], v[144:147]
    ds_read_b64_tr_b16 a[86:87], v24 offset:38912
    v_mfma_f32_16x16x32_bf16 v[148:151], v[212:215], v[64:67], v[148:151]
    ds_read_b64_tr_b16 a[90:91], v28 offset:38912
    s_waitcnt lgkmcnt(15)
    v_mfma_f32_16x16x32_bf16 v[152:155], v[216:219], v[64:67], v[152:155]
    ds_read_b64_tr_b16 a[94:95], v16 offset:38912
    s_waitcnt lgkmcnt(15)
    v_mfma_f32_16x16x32_bf16 v[156:159], v[220:223], v[64:67], v[156:159]
    s_waitcnt lgkmcnt(10)
    s_add_u32 m0, s101, 36864
    s_nop 0
    buffer_load_dwordx4 v21, s[16:19], s49 offen offset:0 lds
    v_mfma_f32_16x16x32_bf16 v[132:135], v[192:195], v[68:71], v[132:135]
    ds_read_b128 v[64:67], v26 offset:3136
    v_mfma_f32_16x16x32_bf16 v[136:139], v[196:199], v[68:71], v[136:139]
    ds_read_b128 v[168:171], v25 offset:2688
    v_mfma_f32_16x16x32_bf16 v[140:143], v[200:203], v[68:71], v[140:143]
    ds_read_b128 v[172:175], v25 offset:2176
    v_mfma_f32_16x16x32_bf16 v[144:147], v[204:207], v[68:71], v[144:147]
    buffer_load_dwordx4 v22, s[16:19], s49 offen offset:1024 lds
    v_mfma_f32_16x16x32_bf16 v[148:151], v[208:211], v[68:71], v[148:151]
    ds_read_b64_tr_b16 a[96:97], v23 offset:0
    v_mfma_f32_16x16x32_bf16 v[152:155], v[212:215], v[68:71], v[152:155]
    ds_read_b64_tr_b16 a[100:101], v24 offset:0
    v_mfma_f32_16x16x32_bf16 v[156:159], v[216:219], v[68:71], v[156:159]
    ds_read_b64_tr_b16 a[104:105], v28 offset:0
    s_waitcnt lgkmcnt(15)
    v_mfma_f32_16x16x32_bf16 v[136:139], v[192:195], v[72:75], v[136:139]
    ds_read_b128 v[68:71], v26 offset:3648
    v_mfma_f32_16x16x32_bf16 v[140:143], v[196:199], v[72:75], v[140:143]
    ds_read_b128 v[176:179], v25 offset:1664
    v_mfma_f32_16x16x32_bf16 v[144:147], v[200:203], v[72:75], v[144:147]
    ds_read_b128 v[180:183], v25 offset:1152
    v_mfma_f32_16x16x32_bf16 v[148:151], v[204:207], v[72:75], v[148:151]
    ds_read_b64_tr_b16 a[108:109], v16 offset:0
    v_mfma_f32_16x16x32_bf16 v[152:155], v[208:211], v[72:75], v[152:155]
    s_waitcnt lgkmcnt(10)
    buffer_load_dwordx4 v4, s[16:19], s49 offen offset:2048 lds
    v_mfma_f32_16x16x32_bf16 v[156:159], v[212:215], v[72:75], v[156:159]
    buffer_load_dwordx4 v5, s[16:19], s49 offen offset:3072 lds
    v_mfma_f32_16x16x32_bf16 v[140:143], v[192:195], v[76:79], v[140:143]
    ds_read_b128 v[72:75], v26 offset:128
    v_mfma_f32_16x16x32_bf16 v[144:147], v[196:199], v[76:79], v[144:147]
    ds_read_b128 v[184:187], v25 offset:640
    v_mfma_f32_16x16x32_bf16 v[148:151], v[200:203], v[76:79], v[148:151]
    ds_read_b128 v[188:191], v25 offset:128
    v_mfma_f32_16x16x32_bf16 v[152:155], v[204:207], v[76:79], v[152:155]
    ds_read_b64_tr_b16 a[98:99], v23 offset:2048
    v_mfma_f32_16x16x32_bf16 v[156:159], v[208:211], v[76:79], v[156:159]
    ds_read_b64_tr_b16 a[102:103], v24 offset:2048
    v_mfma_f32_16x16x32_bf16 v[144:147], v[192:195], v[56:59], v[144:147]
    ds_read_b128 v[76:79], v26 offset:640
    v_mfma_f32_16x16x32_bf16 v[148:151], v[196:199], v[56:59], v[148:151]
    ds_read_b64_tr_b16 a[106:107], v28 offset:2048
    v_mfma_f32_16x16x32_bf16 v[152:155], v[200:203], v[56:59], v[152:155]
    ds_read_b64_tr_b16 a[110:111], v16 offset:2048
    v_mfma_f32_16x16x32_bf16 v[156:159], v[204:207], v[56:59], v[156:159]
    s_waitcnt lgkmcnt(8)
    s_add_u32 m0, s101, 0
    s_nop 0
    buffer_load_dwordx4 v21, s[16:19], s50 offen offset:0 lds
    v_mfma_f32_16x16x32_bf16 v[148:151], v[192:195], v[60:63], v[148:151]
    ds_read_b128 v[56:59], v26 offset:1152
    v_mfma_f32_16x16x32_bf16 v[152:155], v[196:199], v[60:63], v[152:155]
    buffer_load_dwordx4 v22, s[16:19], s50 offen offset:1024 lds
    v_mfma_f32_16x16x32_bf16 v[156:159], v[200:203], v[60:63], v[156:159]
    ds_read_b64_tr_b16 a[112:113], v23 offset:4096
    v_mfma_f32_16x16x32_bf16 v[152:155], v[192:195], v[64:67], v[152:155]
    ds_read_b128 v[60:63], v26 offset:1664
    v_mfma_f32_16x16x32_bf16 v[156:159], v[196:199], v[64:67], v[156:159]
    ds_read_b64_tr_b16 a[116:117], v24 offset:4096
    v_mfma_f32_16x16x32_bf16 v[156:159], v[192:195], v[68:71], v[156:159]
    ds_read_b128 v[64:67], v26 offset:2176
    s_waitcnt lgkmcnt(12)
    v_mfma_f32_16x16x32_bf16 v[128:131], v[160:163], v[72:75], v[128:131]
    ds_read_b128 v[68:71], v26 offset:2688
    v_mfma_f32_16x16x32_bf16 v[132:135], v[164:167], v[72:75], v[132:135]
    ds_read_b128 v[192:195], v25 offset:3776
    v_mfma_f32_16x16x32_bf16 v[136:139], v[168:171], v[72:75], v[136:139]
    ds_read_b128 v[196:199], v25 offset:3264
    v_mfma_f32_16x16x32_bf16 v[140:143], v[172:175], v[72:75], v[140:143]
    ds_read_b64_tr_b16 a[120:121], v28 offset:4096
    v_mfma_f32_16x16x32_bf16 v[144:147], v[176:179], v[72:75], v[144:147]
    ds_read_b64_tr_b16 a[124:125], v16 offset:4096
    v_mfma_f32_16x16x32_bf16 v[148:151], v[180:183], v[72:75], v[148:151]
    s_waitcnt lgkmcnt(10)
    buffer_load_dwordx4 v4, s[16:19], s50 offen offset:2048 lds
    v_mfma_f32_16x16x32_bf16 v[152:155], v[184:187], v[72:75], v[152:155]
    buffer_load_dwordx4 v5, s[16:19], s50 offen offset:3072 lds
    v_mfma_f32_16x16x32_bf16 v[156:159], v[188:191], v[72:75], v[156:159]
    s_waitcnt vmcnt(13)
    ds_read_b64_tr_b16 a[114:115], v23 offset:6144
    v_mfma_f32_16x16x32_bf16 v[132:135], v[160:163], v[76:79], v[132:135]
    ds_read_b128 v[72:75], v26 offset:3200
    v_mfma_f32_16x16x32_bf16 v[136:139], v[164:167], v[76:79], v[136:139]
    ds_read_b128 v[200:203], v25 offset:2752
    v_mfma_f32_16x16x32_bf16 v[140:143], v[168:171], v[76:79], v[140:143]
    ds_read_b128 v[204:207], v25 offset:2240
    v_mfma_f32_16x16x32_bf16 v[144:147], v[172:175], v[76:79], v[144:147]
    ds_read_b64_tr_b16 a[118:119], v24 offset:6144
    v_mfma_f32_16x16x32_bf16 v[148:151], v[176:179], v[76:79], v[148:151]
    ds_read_b64_tr_b16 a[122:123], v28 offset:6144
    v_mfma_f32_16x16x32_bf16 v[152:155], v[180:183], v[76:79], v[152:155]
    ds_read_b64_tr_b16 a[126:127], v16 offset:6144
    v_mfma_f32_16x16x32_bf16 v[156:159], v[184:187], v[76:79], v[156:159]
    s_waitcnt lgkmcnt(7)
    s_add_u32 m0, s101, 4096
    s_nop 0
    buffer_load_dwordx4 v21, s[16:19], s51 offen offset:0 lds
    v_mfma_f32_16x16x32_bf16 v[136:139], v[160:163], v[56:59], v[136:139]
    ds_read_b128 v[76:79], v26 offset:3712
    v_mfma_f32_16x16x32_bf16 v[140:143], v[164:167], v[56:59], v[140:143]
    ds_read_b128 v[208:211], v25 offset:1728
    v_mfma_f32_16x16x32_bf16 v[144:147], v[168:171], v[56:59], v[144:147]
    ds_read_b128 v[212:215], v25 offset:1216
    v_mfma_f32_16x16x32_bf16 v[148:151], v[172:175], v[56:59], v[148:151]
    buffer_load_dwordx4 v22, s[16:19], s51 offen offset:1024 lds
    v_mfma_f32_16x16x32_bf16 v[152:155], v[176:179], v[56:59], v[152:155]
    v_mov_b32 v20, 8
    s_mov_b64 exec, 1
    v_mov_b32 v20, 0
    buffer_atomic_add v20, off, s[20:23], s90 sc0 sc1
    s_mov_b64 exec, -1
    v_mfma_f32_16x16x32_bf16 v[156:159], v[180:183], v[56:59], v[156:159]
    s_waitcnt vmcnt(14)
    ds_read_b64_tr_b16 a[128:129], v23 offset:32768
    v_mfma_f32_16x16x32_bf16 v[140:143], v[160:163], v[60:63], v[140:143]
    ds_read_b128 v[56:59], v26 offset:192
    v_mfma_f32_16x16x32_bf16 v[144:147], v[164:167], v[60:63], v[144:147]
    ds_read_b128 v[216:219], v25 offset:704
    v_mfma_f32_16x16x32_bf16 v[148:151], v[168:171], v[60:63], v[148:151]
    ds_read_b128 v[220:223], v25 offset:192
    v_mfma_f32_16x16x32_bf16 v[152:155], v[172:175], v[60:63], v[152:155]
    ds_read_b64_tr_b16 a[132:133], v24 offset:32768
    v_mfma_f32_16x16x32_bf16 v[156:159], v[176:179], v[60:63], v[156:159]
    ds_read_b64_tr_b16 a[136:137], v28 offset:32768
    v_mfma_f32_16x16x32_bf16 v[144:147], v[160:163], v[64:67], v[144:147]
    ds_read_b128 v[60:63], v26 offset:704
    v_mfma_f32_16x16x32_bf16 v[148:151], v[164:167], v[64:67], v[148:151]
    ds_read_b64_tr_b16 a[140:141], v16 offset:32768
    v_mfma_f32_16x16x32_bf16 v[152:155], v[168:171], v[64:67], v[152:155]
    s_waitcnt lgkmcnt(11)
    buffer_load_dwordx4 v4, s[16:19], s51 offen offset:2048 lds
    v_mfma_f32_16x16x32_bf16 v[156:159], v[172:175], v[64:67], v[156:159]
    buffer_load_dwordx4 v5, s[16:19], s51 offen offset:3072 lds
    v_mfma_f32_16x16x32_bf16 v[148:151], v[160:163], v[68:71], v[148:151]
    ds_read_b128 v[64:67], v26 offset:1216
    v_mfma_f32_16x16x32_bf16 v[152:155], v[164:167], v[68:71], v[152:155]
    s_waitcnt vmcnt(14)
    ds_read_b64_tr_b16 a[130:131], v23 offset:34816
    v_mfma_f32_16x16x32_bf16 v[156:159], v[168:171], v[68:71], v[156:159]
    ds_read_b64_tr_b16 a[134:135], v24 offset:34816
    v_mfma_f32_16x16x32_bf16 v[152:155], v[160:163], v[72:75], v[152:155]
    ds_read_b128 v[68:71], v26 offset:1728
    v_mfma_f32_16x16x32_bf16 v[156:159], v[164:167], v[72:75], v[156:159]
    ds_read_b64_tr_b16 a[138:139], v28 offset:34816
    s_waitcnt lgkmcnt(15)
    v_mfma_f32_16x16x32_bf16 v[156:159], v[160:163], v[76:79], v[156:159]
    ds_read_b128 v[72:75], v26 offset:2240
    s_waitcnt lgkmcnt(12)
    v_mfma_f32_16x16x32_bf16 v[128:131], v[192:195], v[56:59], v[128:131]
    ds_read_b128 v[76:79], v26 offset:2752
    v_mfma_f32_16x16x32_bf16 v[132:135], v[196:199], v[56:59], v[132:135]
    ds_read_b64_tr_b16 a[142:143], v16 offset:34816
    v_mfma_f32_16x16x32_bf16 v[136:139], v[200:203], v[56:59], v[136:139]
    s_waitcnt lgkmcnt(8)
    s_add_u32 m0, s101, 32768
    s_nop 0
    buffer_load_dwordx4 v21, s[16:19], s52 offen offset:0 lds
    v_mfma_f32_16x16x32_bf16 v[140:143], v[204:207], v[56:59], v[140:143]
    buffer_load_dwordx4 v22, s[16:19], s52 offen offset:1024 lds
    v_mfma_f32_16x16x32_bf16 v[144:147], v[208:211], v[56:59], v[144:147]
    s_waitcnt vmcnt(13)
    ds_read_b64_tr_b16 a[144:145], v23 offset:36864
    v_mfma_f32_16x16x32_bf16 v[148:151], v[212:215], v[56:59], v[148:151]
    ds_read_b64_tr_b16 a[148:149], v24 offset:36864
    v_mfma_f32_16x16x32_bf16 v[152:155], v[216:219], v[56:59], v[152:155]
    ds_read_b64_tr_b16 a[152:153], v28 offset:36864
    v_mfma_f32_16x16x32_bf16 v[156:159], v[220:223], v[56:59], v[156:159]
    ds_read_b64_tr_b16 a[156:157], v16 offset:36864
    v_mfma_f32_16x16x32_bf16 v[132:135], v[192:195], v[60:63], v[132:135]
    ds_read_b128 v[56:59], v26 offset:3264
    v_mfma_f32_16x16x32_bf16 v[136:139], v[196:199], v[60:63], v[136:139]
    s_waitcnt lgkmcnt(5)
    buffer_load_dwordx4 v4, s[16:19], s52 offen offset:2048 lds
    v_mfma_f32_16x16x32_bf16 v[140:143], v[200:203], v[60:63], v[140:143]
    buffer_load_dwordx4 v5, s[16:19], s52 offen offset:3072 lds
    v_mfma_f32_16x16x32_bf16 v[144:147], v[204:207], v[60:63], v[144:147]
    s_waitcnt vmcnt(13)
    ds_read_b64_tr_b16 a[146:147], v23 offset:38912
    v_mfma_f32_16x16x32_bf16 v[148:151], v[208:211], v[60:63], v[148:151]
    ds_read_b64_tr_b16 a[150:151], v24 offset:38912
    v_mfma_f32_16x16x32_bf16 v[152:155], v[212:215], v[60:63], v[152:155]
    ds_read_b64_tr_b16 a[154:155], v28 offset:38912
    v_mfma_f32_16x16x32_bf16 v[156:159], v[216:219], v[60:63], v[156:159]
    ds_read_b64_tr_b16 a[158:159], v16 offset:38912
    v_mfma_f32_16x16x32_bf16 v[136:139], v[192:195], v[64:67], v[136:139]
    ds_read_b128 v[60:63], v26 offset:3776
    v_mfma_f32_16x16x32_bf16 v[140:143], v[196:199], v[64:67], v[140:143]
    s_waitcnt lgkmcnt(6)
    s_add_u32 m0, s101, 36864
    s_nop 0
    buffer_load_dwordx4 v21, s[16:19], s53 offen offset:0 lds
    v_mfma_f32_16x16x32_bf16 v[144:147], v[200:203], v[64:67], v[144:147]
    buffer_load_dwordx4 v22, s[16:19], s53 offen offset:1024 lds
    v_mfma_f32_16x16x32_bf16 v[148:151], v[204:207], v[64:67], v[148:151]
    s_waitcnt vmcnt(13)
    ds_read_b64_tr_b16 a[160:161], v23 offset:0
    v_mfma_f32_16x16x32_bf16 v[152:155], v[208:211], v[64:67], v[152:155]
    ds_read_b64_tr_b16 a[164:165], v24 offset:0
    v_mfma_f32_16x16x32_bf16 v[156:159], v[212:215], v[64:67], v[156:159]
    ds_read_b64_tr_b16 a[168:169], v28 offset:0
    v_mfma_f32_16x16x32_bf16 v[140:143], v[192:195], v[68:71], v[140:143]
    ds_read_b64_tr_b16 a[172:173], v16 offset:0
    v_mfma_f32_16x16x32_bf16 v[144:147], v[196:199], v[68:71], v[144:147]
    s_waitcnt lgkmcnt(5)
    buffer_load_dwordx4 v4, s[16:19], s53 offen offset:2048 lds
    v_mfma_f32_16x16x32_bf16 v[148:151], v[200:203], v[68:71], v[148:151]
    buffer_load_dwordx4 v5, s[16:19], s53 offen offset:3072 lds
    v_mfma_f32_16x16x32_bf16 v[152:155], v[204:207], v[68:71], v[152:155]
    s_waitcnt vmcnt(10)
    v_cmp_gt_u32 vcc, 8, v20
    s_nop 0
    s_cmp_eq_u64 vcc, 0
    s_cbranch_scc1 L_ok2
    s_mov_b32 s3, 262144
L_poll2:
    s_sleep 2
    v_mov_b32 v20, 8
    s_mov_b64 exec, 1
    v_mov_b32 v20, 0
    buffer_atomic_add v20, off, s[20:23], s90 sc0 sc1
    s_mov_b64 exec, -1
    s_waitcnt vmcnt(0)
    v_cmp_gt_u32 vcc, 8, v20
    s_nop 0
    s_cmp_eq_u64 vcc, 0
    s_cbranch_scc1 L_ok2
    s_sub_u32 s3, s3, 1
    s_cmp_lg_u32 s3, 0
    s_cbranch_scc1 L_poll2
L_ok2:
    v_mfma_f32_16x16x32_bf16 v[156:159], v[208:211], v[68:71], v[156:159]
    buffer_load_dwordx4 v[80:83], v9, s[20:23], s92 offen sc1
    v_mfma_f32_16x16x32_bf16 v[144:147], v[192:195], v[72:75], v[144:147]
    buffer_load_dwordx4 v[84:87], v10, s[20:23], s92 offen sc1
    v_mfma_f32_16x16x32_bf16 v[148:151], v[196:199], v[72:75], v[148:151]
    buffer_load_dwordx4 v[88:91], v7, s[20:23], s92 offen sc1
    v_mfma_f32_16x16x32_bf16 v[152:155], v[200:203], v[72:75], v[152:155]
    buffer_load_dwordx4 v[92:95], v3, s[20:23], s92 offen sc1
    s_add_u32 s92, s92, 4096
    v_mfma_f32_16x16x32_bf16 v[156:159], v[204:207], v[72:75], v[156:159]
    buffer_load_dwordx4 v[96:99], v9, s[20:23], s92 offen sc1
    v_mfma_f32_16x16x32_bf16 v[148:151], v[192:195], v[76:79], v[148:151]
    buffer_load_dwordx4 v[100:103], v10, s[20:23], s92 offen sc1
    v_mfma_f32_16x16x32_bf16 v[152:155], v[196:199], v[76:79], v[152:155]
    buffer_load_dwordx4 v[104:107], v7, s[20:23], s92 offen sc1
    v_mfma_f32_16x16x32_bf16 v[156:159], v[200:203], v[76:79], v[156:159]
    buffer_load_dwordx4 v[108:111], v3, s[20:23], s92 offen sc1
    s_add_u32 s92, s92, 4096
    v_mfma_f32_16x16x32_bf16 v[152:155], v[192:195], v[56:59], v[152:155]
    buffer_load_dwordx4 v[112:115], v9, s[20:23], s92 offen sc1
    v_mfma_f32_16x16x32_bf16 v[156:159], v[196:199], v[56:59], v[156:159]
    buffer_load_dwordx4 v[116:119], v10, s[20:23], s92 offen sc1
    s_waitcnt lgkmcnt(4)
    v_mfma_f32_16x16x32_bf16 v[156:159], v[192:195], v[60:63], v[156:159]
    s_nop 3
    v_lshl_add_u32 v8, v1, 3, s95
    v_xor_b32 v11, 4096, v8
    s_lshl_b32 s75, s68, 11
    s_add_u32 s75, s75, 20992
    v_lshl_add_u32 v12, v1, 2, s75
    v_add_u32 v13, s75, v2
    ds_write_b64 v8, v[130:131] offset:0
    ds_write_b64 v8, v[134:135] offset:512
    ds_write_b64 v8, v[138:139] offset:1024
    ds_write_b64 v8, v[142:143] offset:1536
    ds_write_b64 v8, v[146:147] offset:2048
    ds_write_b64 v8, v[150:151] offset:2560
    ds_write_b64 v8, v[154:155] offset:3072
    ds_write_b64 v8, v[158:159] offset:3584
    s_waitcnt lgkmcnt(0)
    s_barrier
    s_waitcnt vmcnt(8)
    v_mfma_f32_16x16x32_bf16 v[192:195], a[0:3], v[80:83], 0
    buffer_load_dwordx4 v[120:123], v7, s[20:23], s92 offen sc1
    v_mfma_f32_16x16x32_bf16 v[208:211], a[0:3], v[84:87], 0
    buffer_load_dwordx4 v[124:127], v3, s[20:23], s92 offen sc1
    s_add_u32 s92, s92, 4096
    v_mfma_f32_16x16x32_bf16 v[212:215], a[4:7], v[84:87], 0
    buffer_load_dwordx4 v[32:35], v9, s[20:23], s92 offen sc1
    v_mfma_f32_16x16x32_bf16 v[196:199], a[4:7], v[80:83], 0
    buffer_load_dwordx4 v[36:39], v10, s[20:23], s92 offen sc1
    v_mfma_f32_16x16x32_bf16 v[200:203], a[8:11], v[80:83], 0
    ds_read_b64 v[130:131], v11 offset:0
    v_mfma_f32_16x16x32_bf16 v[216:219], a[8:11], v[84:87], 0
    ds_read_b64 v[134:135], v11 offset:512
    v_mfma_f32_16x16x32_bf16 v[220:223], a[12:15], v[84:87], 0
    ds_read_b64 v[138:139], v11 offset:1024
    v_mfma_f32_16x16x32_bf16 v[204:207], a[12:15], v[80:83], 0
    ds_read_b64 v[142:143], v11 offset:1536
    s_waitcnt vmcnt(10)
    v_mfma_f32_16x16x32_bf16 v[224:227], a[0:3], v[88:91], 0
    buffer_load_dwordx4 v[40:43], v7, s[20:23], s92 offen sc1
    v_mfma_f32_16x16x32_bf16 v[240:243], a[0:3], v[92:95], 0
    buffer_load_dwordx4 v[44:47], v3, s[20:23], s92 offen sc1
    s_add_u32 s92, s92, 4096
    v_mfma_f32_16x16x32_bf16 v[244:247], a[4:7], v[92:95], 0
    ds_read_b64 v[146:147], v11 offset:2048
    v_mfma_f32_16x16x32_bf16 v[228:231], a[4:7], v[88:91], 0
    ds_read_b64 v[150:151], v11 offset:2560
    v_mfma_f32_16x16x32_bf16 v[232:235], a[8:11], v[88:91], 0
    ds_read_b64 v[154:155], v11 offset:3072
    v_mfma_f32_16x16x32_bf16 v[248:251], a[8:11], v[92:95], 0
    ds_read_b64 v[158:159], v11 offset:3584
    v_mfma_f32_16x16x32_bf16 v[252:255], a[12:15], v[92:95], 0
    s_waitcnt lgkmcnt(7)
    v_add_f32 v128, v128, v130
    v_add_f32 v129, v129, v131
    v_mfma_f32_16x16x32_bf16 v[236:239], a[12:15], v[88:91], 0
    v_cvt_pk_bf16_f32 v128, v128, v129
    ds_write_b32 v12, v128 offset:0
    s_waitcnt vmcnt(10)
    v_mfma_f32_16x16x32_bf16 v[192:195], a[16:19], v[96:99], v[192:195]
    buffer_load_dwordx4 v[48:51], v9, s[20:23], s92 offen sc1
    v_mfma_f32_16x16x32_bf16 v[208:211], a[16:19], v[100:103], v[208:211]
    buffer_load_dwordx4 v[52:55], v10, s[20:23], s92 offen sc1
    v_mfma_f32_16x16x32_bf16 v[212:215], a[20:23], v[100:103], v[212:215]
    s_waitcnt lgkmcnt(7)
    v_add_f32 v132, v132, v134
    v_add_f32 v133, v133, v135
    v_mfma_f32_16x16x32_bf16 v[196:199], a[20:23], v[96:99], v[196:199]
    v_cvt_pk_bf16_f32 v132, v132, v133
    ds_write_b32 v12, v132 offset:256
    v_mfma_f32_16x16x32_bf16 v[200:203], a[24:27], v[96:99], v[200:203]
    s_waitcnt lgkmcnt(7)
    v_add_f32 v136, v136, v138
    v_add_f32 v137, v137, v139
    v_mfma_f32_16x16x32_bf16 v[216:219], a[24:27], v[100:103], v[216:219]
    v_cvt_pk_bf16_f32 v136, v136, v137
    ds_write_b32 v12, v136 offset:512
    v_mfma_f32_16x16x32_bf16 v[220:223], a[28:31], v[100:103], v[220:223]
    s_waitcnt lgkmcnt(7)
    v_add_f32 v140, v140, v142
    v_add_f32 v141, v141, v143
    v_mfma_f32_16x16x32_bf16 v[204:207], a[28:31], v[96:99], v[204:207]
    v_cvt_pk_bf16_f32 v140, v140, v141
    ds_write_b32 v12, v140 offset:768
    s_waitcnt vmcnt(10)
    v_mfma_f32_16x16x32_bf16 v[224:227], a[16:19], v[104:107], v[224:227]
    buffer_load_dwordx4 v[56:59], v7, s[20:23], s92 offen sc1
    v_mfma_f32_16x16x32_bf16 v[240:243], a[16:19], v[108:111], v[240:243]
    buffer_load_dwordx4 v[60:63], v3, s[20:23], s92 offen sc1
    s_add_u32 s92, s92, 4096
    v_mfma_f32_16x16x32_bf16 v[244:247], a[20:23], v[108:111], v[244:247]
    s_waitcnt lgkmcnt(7)
    v_add_f32 v144, v144, v146
    v_add_f32 v145, v145, v147
    v_mfma_f32_16x16x32_bf16 v[228:231], a[20:23], v[104:107], v[228:231]
    v_cvt_pk_bf16_f32 v144, v144, v145
    ds_write_b32 v12, v144 offset:1024
    v_mfma_f32_16x16x32_bf16 v[232:235], a[24:27], v[104:107], v[232:235]
    s_waitcnt lgkmcnt(7)
    v_add_f32 v148, v148, v150
    v_add_f32 v149, v149, v151
    v_mfma_f32_16x16x32_bf16 v[248:251], a[24:27], v[108:111], v[248:251]
    v_cvt_pk_bf16_f32 v148, v148, v149
    ds_write_b32 v12, v148 offset:1280
    v_mfma_f32_16x16x32_bf16 v[252:255], a[28:31], v[108:111], v[252:255]
    s_waitcnt lgkmcnt(7)
    v_add_f32 v152, v152, v154
    v_add_f32 v153, v153, v155
    v_mfma_f32_16x16x32_bf16 v[236:239], a[28:31], v[104:107], v[236:239]
    v_cvt_pk_bf16_f32 v152, v152, v153
    ds_write_b32 v12, v152 offset:1536
    s_waitcnt vmcnt(10)
    v_mfma_f32_16x16x32_bf16 v[192:195], a[32:35], v[112:115], v[192:195]
    buffer_load_dwordx4 v[64:67], v9, s[20:23], s92 offen sc1
    v_mfma_f32_16x16x32_bf16 v[208:211], a[32:35], v[116:119], v[208:211]
    buffer_load_dwordx4 v[68:71], v10, s[20:23], s92 offen sc1
    v_mfma_f32_16x16x32_bf16 v[212:215], a[36:39], v[116:119], v[212:215]
    s_waitcnt lgkmcnt(7)
    v_add_f32 v156, v156, v158
    v_add_f32 v157, v157, v159
    v_mfma_f32_16x16x32_bf16 v[196:199], a[36:39], v[112:115], v[196:199]
    v_cvt_pk_bf16_f32 v156, v156, v157
    ds_write_b32 v12, v156 offset:1792
    v_mfma_f32_16x16x32_bf16 v[200:203], a[40:43], v[112:115], v[200:203]
    s_waitcnt lgkmcnt(0)
    ds_read_b128 v[128:131], v13
    v_mfma_f32_16x16x32_bf16 v[216:219], a[40:43], v[116:119], v[216:219]
    ds_read_b128 v[132:135], v13 offset:1024
    v_mfma_f32_16x16x32_bf16 v[220:223], a[44:47], v[116:119], v[220:223]
    s_waitcnt lgkmcnt(1)
    buffer_store_dwordx4 v[128:131], v2, s[20:23], s84 offen sc1
    v_mfma_f32_16x16x32_bf16 v[204:207], a[44:47], v[112:115], v[204:207]
    s_waitcnt lgkmcnt(0)
    buffer_store_dwordx4 v[132:135], v2, s[20:23], s84 offen offset:1024 sc1
    s_waitcnt vmcnt(12)
    v_mfma_f32_16x16x32_bf16 v[224:227], a[32:35], v[120:123], v[224:227]
    buffer_load_dwordx4 v[72:75], v7, s[20:23], s92 offen sc1
    s_lshl_b32 s75, s72, 1
    v_mfma_f32_16x16x32_bf16 v[240:243], a[32:35], v[124:127], v[240:243]
    buffer_load_dwordx4 v[76:79], v3, s[20:23], s92 offen sc1
    s_add_u32 s92, s92, 4096
    v_mfma_f32_16x16x32_bf16 v[244:247], a[36:39], v[124:127], v[244:247]
    s_add_u32 s75, s75, s74
    s_lshl_b32 s75, s75, 1
    s_lshr_b32 s97, s71, 4
    v_mfma_f32_16x16x32_bf16 v[228:231], a[36:39], v[120:123], v[228:231]
    s_add_u32 s97, s75, s97
    s_lshl_b32 s97, s97, 7
    s_add_u32 s91, s97, 12664832
    v_mfma_f32_16x16x32_bf16 v[232:235], a[40:43], v[120:123], v[232:235]
    s_add_u32 s75, s75, s73
    s_lshl_b32 s75, s75, 7
    s_add_u32 s89, s75, 12664832
    v_mfma_f32_16x16x32_bf16 v[248:251], a[40:43], v[124:127], v[248:251]
    s_lshl2_add_u32 s75, s71, s68
    s_lshl_b32 s96, s75, 4
    v_and_b32 v11, 15, v1
    v_mfma_f32_16x16x32_bf16 v[252:255], a[44:47], v[124:127], v[252:255]
    v_lshlrev_b32 v21, 7, v11
    v_add_lshl_u32 v11, v11, s96, 2
    v_mfma_f32_16x16x32_bf16 v[236:239], a[44:47], v[120:123], v[236:239]
    v_lshrrev_b32 v30, 4, v1
    v_lshl_add_u32 v21, v30, 3, v21
    s_waitcnt vmcnt(12)
    v_mfma_f32_16x16x32_bf16 v[192:195], a[48:51], v[32:35], v[192:195]
    buffer_load_dwordx4 v[160:163], v9, s[20:23], s92 offen sc1
    s_mul_i32 s99, s96, 896
    v_mfma_f32_16x16x32_bf16 v[208:211], a[48:51], v[36:39], v[208:211]
    buffer_load_dwordx4 v[164:167], v10, s[20:23], s92 offen sc1
    s_lshl_b32 s75, s72, 7
    v_mfma_f32_16x16x32_bf16 v[212:215], a[52:55], v[36:39], v[212:215]
    s_add_u32 s99, s99, s75
    v_and_b32 v22, 7, v1
    v_mfma_f32_16x16x32_bf16 v[196:199], a[52:55], v[32:35], v[196:199]
    v_lshlrev_b32 v25, 4, v22
    v_mul_u32_u24 v22, 896, v22
    v_mfma_f32_16x16x32_bf16 v[200:203], a[56:59], v[32:35], v[200:203]
    v_bfe_u32 v30, v1, 3, 1
    v_lshl_add_u32 v22, v30, 6, v22
    v_mfma_f32_16x16x32_bf16 v[216:219], a[56:59], v[36:39], v[216:219]
    v_bfe_u32 v30, v1, 4, 1
    v_lshl_add_u32 v22, v30, 5, v22
    v_mfma_f32_16x16x32_bf16 v[220:223], a[60:63], v[36:39], v[220:223]
    v_lshrrev_b32 v30, 5, v1
    v_lshl_add_u32 v22, v30, 4, v22
    v_mfma_f32_16x16x32_bf16 v[204:207], a[60:63], v[32:35], v[204:207]
    v_lshrrev_b32 v30, 3, v1
    v_mul_u32_u24 v30, 896, v30
    s_waitcnt vmcnt(12)
    v_mfma_f32_16x16x32_bf16 v[224:227], a[48:51], v[40:43], v[224:227]
    buffer_load_dwordx4 v[168:171], v7, s[20:23], s92 offen sc1
    v_add_u32 v25, v25, v30
    v_mfma_f32_16x16x32_bf16 v[240:243], a[48:51], v[44:47], v[240:243]
    buffer_load_dwordx4 v[172:175], v3, s[20:23], s92 offen sc1
    s_add_u32 s92, s92, 4096
    v_mfma_f32_16x16x32_bf16 v[244:247], a[52:55], v[44:47], v[244:247]
    v_add_u32 v26, 6144, v25
    s_lshl_b32 s96, s68, 11
    v_mfma_f32_16x16x32_bf16 v[228:231], a[52:55], v[40:43], v[228:231]
    v_add_u32 v21, s96, v21
    s_lshl_b32 s75, s73, 11
    v_mfma_f32_16x16x32_bf16 v[232:235], a[56:59], v[40:43], v[232:235]
    s_lshl_b32 s98, s74, 5
    s_add_u32 s75, s75, s98
    v_add_u32 v0, s75, v0
    v_mfma_f32_16x16x32_bf16 v[248:251], a[56:59], v[44:47], v[248:251]
    s_lshl1_add_u32 s98, s72, s73
    v_lshrrev_b32 v14, 2, v1
    v_mfma_f32_16x16x32_bf16 v[252:255], a[60:63], v[44:47], v[252:255]
    v_and_b32 v30, 3, v1
    v_lshlrev_b32 v14, 12, v14
    v_mfma_f32_16x16x32_bf16 v[236:239], a[60:63], v[40:43], v[236:239]
    v_lshl_add_u32 v14, v30, 4, v14
    v_add_u32 v15, 64512, v14
    s_waitcnt vmcnt(12)
    v_mfma_f32_16x16x32_bf16 v[192:195], a[64:67], v[48:51], v[192:195]
    buffer_load_dwordx4 v[176:179], v9, s[20:23], s92 offen sc1
    s_lshl_b32 s98, s98, 17
    v_mfma_f32_16x16x32_bf16 v[208:211], a[64:67], v[52:55], v[208:211]
    buffer_load_dwordx4 v[180:183], v10, s[20:23], s92 offen sc1
    s_lshl_b32 s75, s74, 11
    v_mfma_f32_16x16x32_bf16 v[212:215], a[68:71], v[52:55], v[212:215]
    s_add_u32 s98, s98, s75
    s_lshl_b32 s75, s71, 6
    s_add_u32 s98, s98, s75
    v_mfma_f32_16x16x32_bf16 v[196:199], a[68:71], v[48:51], v[196:199]
    s_add_u32 s98, s98, 10485760
    s_mov_b32 s97, 12582912
    s_xor_b32 s75, s68, 0
    v_mfma_f32_16x16x32_bf16 v[200:203], a[72:75], v[48:51], v[200:203]
    s_mul_i32 s75, s75, 12288
    s_add_u32 s75, s75, 114688
    v_add_u32 v17, s75, v2
    v_mfma_f32_16x16x32_bf16 v[216:219], a[72:75], v[52:55], v[216:219]
    s_xor_b32 s75, s68, 1
    s_mul_i32 s75, s75, 12288
    s_add_u32 s75, s75, 114688
    v_mfma_f32_16x16x32_bf16 v[220:223], a[76:79], v[52:55], v[220:223]
    v_add_u32 v18, s75, v2
    s_xor_b32 s75, s68, 2
    v_mfma_f32_16x16x32_bf16 v[204:207], a[76:79], v[48:51], v[204:207]
    s_mul_i32 s75, s75, 12288
    s_add_u32 s75, s75, 118784
    v_add_u32 v19, s75, v2
    s_waitcnt vmcnt(12)
    v_mfma_f32_16x16x32_bf16 v[224:227], a[64:67], v[56:59], v[224:227]
    buffer_load_dwordx4 v[184:187], v7, s[20:23], s92 offen sc1
    s_xor_b32 s75, s68, 3
    v_mfma_f32_16x16x32_bf16 v[240:243], a[64:67], v[60:63], v[240:243]
    buffer_load_dwordx4 v[188:191], v3, s[20:23], s92 offen sc1
    s_add_u32 s92, s92, 4096
    v_mfma_f32_16x16x32_bf16 v[244:247], a[68:71], v[60:63], v[244:247]
    s_mul_i32 s75, s75, 12288
    s_add_u32 s75, s75, 122880
    v_add_u32 v27, s75, v2
    v_mfma_f32_16x16x32_bf16 v[228:231], a[68:71], v[56:59], v[228:231]
    v_mov_b32 v31, 1
    s_waitcnt vmcnt(10)
    s_mov_b64 exec, 1
    buffer_atomic_add v31, off, s[20:23], s91 sc1
    s_mov_b64 exec, -1
    v_mfma_f32_16x16x32_bf16 v[232:235], a[72:75], v[56:59], v[232:235]
    v_mfma_f32_16x16x32_bf16 v[248:251], a[72:75], v[60:63], v[248:251]
    v_mfma_f32_16x16x32_bf16 v[252:255], a[76:79], v[60:63], v[252:255]
    v_mfma_f32_16x16x32_bf16 v[236:239], a[76:79], v[56:59], v[236:239]
    v_mfma_f32_16x16x32_bf16 v[192:195], a[80:83], v[64:67], v[192:195]
    buffer_load_dwordx4 v[80:83], v9, s[20:23], s92 offen sc1
    v_mfma_f32_16x16x32_bf16 v[208:211], a[80:83], v[68:71], v[208:211]
    buffer_load_dwordx4 v[84:87], v10, s[20:23], s92 offen sc1
    v_mfma_f32_16x16x32_bf16 v[212:215], a[84:87], v[68:71], v[212:215]
    s_add_u32 m0, s96, 40960
    s_nop 0
    buffer_load_dwordx4 v25, s[4:7], s99 offen lds
    v_mfma_f32_16x16x32_bf16 v[196:199], a[84:87], v[64:67], v[196:199]
    buffer_load_dwordx4 v26, s[4:7], s99 offen offset:1024 lds
    v_mfma_f32_16x16x32_bf16 v[200:203], a[88:91], v[64:67], v[200:203]
    buffer_load_dword v5, v11, s[20:23], s97 offen sc1
    v_mfma_f32_16x16x32_bf16 v[216:219], a[88:91], v[68:71], v[216:219]
    v_mfma_f32_16x16x32_bf16 v[220:223], a[92:95], v[68:71], v[220:223]
    v_mfma_f32_16x16x32_bf16 v[204:207], a[92:95], v[64:67], v[204:207]
    s_waitcnt vmcnt(14)
    v_mfma_f32_16x16x32_bf16 v[224:227], a[80:83], v[72:75], v[224:227]
    buffer_load_dwordx4 v[88:91], v7, s[20:23], s92 offen sc1
    v_mfma_f32_16x16x32_bf16 v[240:243], a[80:83], v[76:79], v[240:243]
    buffer_load_dwordx4 v[92:95], v3, s[20:23], s92 offen sc1
    s_add_u32 s92, s92, 4096
    v_mfma_f32_16x16x32_bf16 v[244:247], a[84:87], v[76:79], v[244:247]
    ds_read_b64_tr_b16 a[162:163], v23 offset:2048
    v_mfma_f32_16x16x32_bf16 v[228:231], a[84:87], v[72:75], v[228:231]
    ds_read_b64_tr_b16 a[166:167], v24 offset:2048
    v_mfma_f32_16x16x32_bf16 v[232:235], a[88:91], v[72:75], v[232:235]
    ds_read_b64_tr_b16 a[170:171], v28 offset:2048
    v_mfma_f32_16x16x32_bf16 v[248:251], a[88:91], v[76:79], v[248:251]
    ds_read_b64_tr_b16 a[174:175], v16 offset:2048
    v_mfma_f32_16x16x32_bf16 v[252:255], a[92:95], v[76:79], v[252:255]
    v_mfma_f32_16x16x32_bf16 v[236:239], a[92:95], v[72:75], v[236:239]
    s_waitcnt vmcnt(14)
    v_mfma_f32_16x16x32_bf16 v[192:195], a[96:99], v[160:163], v[192:195]
    buffer_load_dwordx4 v[96:99], v9, s[20:23], s92 offen sc1
    v_mfma_f32_16x16x32_bf16 v[208:211], a[96:99], v[164:167], v[208:211]
    buffer_load_dwordx4 v[100:103], v10, s[20:23], s92 offen sc1
    v_mfma_f32_16x16x32_bf16 v[212:215], a[100:103], v[164:167], v[212:215]
    ds_read_b64_tr_b16 a[176:177], v23 offset:4096
    v_mfma_f32_16x16x32_bf16 v[196:199], a[100:103], v[160:163], v[196:199]
    ds_read_b64_tr_b16 a[180:181], v24 offset:4096
    v_mfma_f32_16x16x32_bf16 v[200:203], a[104:107], v[160:163], v[200:203]
    ds_read_b64_tr_b16 a[184:185], v28 offset:4096
    v_mfma_f32_16x16x32_bf16 v[216:219], a[104:107], v[164:167], v[216:219]
    ds_read_b64_tr_b16 a[188:189], v16 offset:4096
    v_mfma_f32_16x16x32_bf16 v[220:223], a[108:111], v[164:167], v[220:223]
    v_mfma_f32_16x16x32_bf16 v[204:207], a[108:111], v[160:163], v[204:207]
    s_waitcnt vmcnt(14)
    v_mfma_f32_16x16x32_bf16 v[224:227], a[96:99], v[168:171], v[224:227]
    buffer_load_dwordx4 v[104:107], v7, s[20:23], s92 offen sc1
    v_mfma_f32_16x16x32_bf16 v[240:243], a[96:99], v[172:175], v[240:243]
    buffer_load_dwordx4 v[108:111], v3, s[20:23], s92 offen sc1
    s_add_u32 s92, s92, 4096
    v_mfma_f32_16x16x32_bf16 v[244:247], a[100:103], v[172:175], v[244:247]
    ds_read_b64_tr_b16 a[178:179], v23 offset:6144
    v_mfma_f32_16x16x32_bf16 v[228:231], a[100:103], v[168:171], v[228:231]
    ds_read_b64_tr_b16 a[182:183], v24 offset:6144
    v_mfma_f32_16x16x32_bf16 v[232:235], a[104:107], v[168:171], v[232:235]
    ds_read_b64_tr_b16 a[186:187], v28 offset:6144
    v_mfma_f32_16x16x32_bf16 v[248:251], a[104:107], v[172:175], v[248:251]
    ds_read_b64_tr_b16 a[190:191], v16 offset:6144
    v_mfma_f32_16x16x32_bf16 v[252:255], a[108:111], v[172:175], v[252:255]
    v_mfma_f32_16x16x32_bf16 v[236:239], a[108:111], v[168:171], v[236:239]
    s_waitcnt vmcnt(14)
    v_mfma_f32_16x16x32_bf16 v[192:195], a[112:115], v[176:179], v[192:195]
    buffer_load_dwordx4 v[112:115], v9, s[20:23], s92 offen sc1
    v_mfma_f32_16x16x32_bf16 v[208:211], a[112:115], v[180:183], v[208:211]
    buffer_load_dwordx4 v[116:119], v10, s[20:23], s92 offen sc1
    v_mfma_f32_16x16x32_bf16 v[212:215], a[116:119], v[180:183], v[212:215]
    ds_read_b64_tr_b16 a[192:193], v23 offset:32768
    v_mfma_f32_16x16x32_bf16 v[196:199], a[116:119], v[176:179], v[196:199]
    ds_read_b64_tr_b16 a[196:197], v24 offset:32768
    v_mfma_f32_16x16x32_bf16 v[200:203], a[120:123], v[176:179], v[200:203]
    ds_read_b64_tr_b16 a[200:201], v28 offset:32768
    v_mfma_f32_16x16x32_bf16 v[216:219], a[120:123], v[180:183], v[216:219]
    ds_read_b64_tr_b16 a[204:205], v16 offset:32768
    v_mfma_f32_16x16x32_bf16 v[220:223], a[124:127], v[180:183], v[220:223]
    v_mfma_f32_16x16x32_bf16 v[204:207], a[124:127], v[176:179], v[204:207]
    s_waitcnt vmcnt(14)
    v_mfma_f32_16x16x32_bf16 v[224:227], a[112:115], v[184:187], v[224:227]
    buffer_load_dwordx4 v[120:123], v7, s[20:23], s92 offen sc1
    v_mfma_f32_16x16x32_bf16 v[240:243], a[112:115], v[188:191], v[240:243]
    buffer_load_dwordx4 v[124:127], v3, s[20:23], s92 offen sc1
    s_add_u32 s92, s92, 4096
    v_mfma_f32_16x16x32_bf16 v[244:247], a[116:119], v[188:191], v[244:247]
    ds_read_b64_tr_b16 a[194:195], v23 offset:34816
    v_mfma_f32_16x16x32_bf16 v[228:231], a[116:119], v[184:187], v[228:231]
    ds_read_b64_tr_b16 a[198:199], v24 offset:34816
    v_mfma_f32_16x16x32_bf16 v[232:235], a[120:123], v[184:187], v[232:235]
    ds_read_b64_tr_b16 a[202:203], v28 offset:34816
    v_mfma_f32_16x16x32_bf16 v[248:251], a[120:123], v[188:191], v[248:251]
    ds_read_b64_tr_b16 a[206:207], v16 offset:34816
    v_mfma_f32_16x16x32_bf16 v[252:255], a[124:127], v[188:191], v[252:255]
    s_waitcnt vmcnt(10)
    ds_read_b64 v[128:129], v21 offset:40960
    v_mfma_f32_16x16x32_bf16 v[236:239], a[124:127], v[184:187], v[236:239]
    ds_read_b64 v[130:131], v21 offset:40992
    v_mfma_f32_16x16x32_bf16 v[192:195], a[128:131], v[80:83], v[192:195]
    buffer_load_dwordx4 v[32:35], v9, s[20:23], s92 offen sc1
    v_mfma_f32_16x16x32_bf16 v[208:211], a[128:131], v[84:87], v[208:211]
    buffer_load_dwordx4 v[36:39], v10, s[20:23], s92 offen sc1
    v_mfma_f32_16x16x32_bf16 v[212:215], a[132:135], v[84:87], v[212:215]
    ds_read_b64_tr_b16 a[208:209], v23 offset:36864
    v_mfma_f32_16x16x32_bf16 v[196:199], a[132:135], v[80:83], v[196:199]
    ds_read_b64_tr_b16 a[212:213], v24 offset:36864
    v_mfma_f32_16x16x32_bf16 v[200:203], a[136:139], v[80:83], v[200:203]
    ds_read_b64_tr_b16 a[216:217], v28 offset:36864
    v_mfma_f32_16x16x32_bf16 v[216:219], a[136:139], v[84:87], v[216:219]
    ds_read_b64_tr_b16 a[220:221], v16 offset:36864
    v_mfma_f32_16x16x32_bf16 v[220:223], a[140:143], v[84:87], v[220:223]
    ds_read_b64 v[132:133], v21 offset:41024
    v_mfma_f32_16x16x32_bf16 v[204:207], a[140:143], v[80:83], v[204:207]
    ds_read_b64 v[134:135], v21 offset:41056
    v_sub_f32 v4, 1.0, v5
    s_waitcnt vmcnt(10)
    v_mfma_f32_16x16x32_bf16 v[224:227], a[128:131], v[88:91], v[224:227]
    buffer_load_dwordx4 v[40:43], v7, s[20:23], s92 offen sc1
    v_mfma_f32_16x16x32_bf16 v[240:243], a[128:131], v[92:95], v[240:243]
    buffer_load_dwordx4 v[44:47], v3, s[20:23], s92 offen sc1
    s_add_u32 s92, s92, 4096
    v_mfma_f32_16x16x32_bf16 v[244:247], a[132:135], v[92:95], v[244:247]
    ds_read_b64_tr_b16 a[210:211], v23 offset:38912
    v_mfma_f32_16x16x32_bf16 v[228:231], a[132:135], v[88:91], v[228:231]
    ds_read_b64_tr_b16 a[214:215], v24 offset:38912
    v_mfma_f32_16x16x32_bf16 v[232:235], a[136:139], v[88:91], v[232:235]
    ds_read_b64_tr_b16 a[218:219], v28 offset:38912
    v_mfma_f32_16x16x32_bf16 v[248:251], a[136:139], v[92:95], v[248:251]
    ds_read_b64_tr_b16 a[222:223], v16 offset:38912
    v_mfma_f32_16x16x32_bf16 v[252:255], a[140:143], v[92:95], v[252:255]
    s_waitcnt lgkmcnt(11)
    v_lshlrev_b32 v144, 16, v128
    v_mfma_f32_16x16x32_bf16 v[236:239], a[140:143], v[88:91], v[236:239]
    v_and_b32 v145, 0xffff0000, v128
    v_mul_f32 v144, v5, v144
    s_waitcnt vmcnt(10)
    v_mfma_f32_16x16x32_bf16 v[192:195], a[144:147], v[96:99], v[192:195]
    buffer_load_dwordx4 v[48:51], v9, s[20:23], s92 offen sc1
    v_mul_f32 v145, v5, v145
    v_mfma_f32_16x16x32_bf16 v[208:211], a[144:147], v[100:103], v[208:211]
    buffer_load_dwordx4 v[52:55], v10, s[20:23], s92 offen sc1
    v_lshlrev_b32 v146, 16, v129
    v_mfma_f32_16x16x32_bf16 v[212:215], a[148:151], v[100:103], v[212:215]
    v_and_b32 v147, 0xffff0000, v129
    v_mul_f32 v146, v5, v146
    v_mfma_f32_16x16x32_bf16 v[196:199], a[148:151], v[96:99], v[196:199]
    v_mul_f32 v147, v5, v147
    v_mfma_f32_16x16x32_bf16 v[200:203], a[152:155], v[96:99], v[200:203]
    s_waitcnt lgkmcnt(10)
    v_lshlrev_b32 v148, 16, v130
    v_mfma_f32_16x16x32_bf16 v[216:219], a[152:155], v[100:103], v[216:219]
    v_and_b32 v149, 0xffff0000, v130
    v_mul_f32 v148, v5, v148
    v_mfma_f32_16x16x32_bf16 v[220:223], a[156:159], v[100:103], v[220:223]
    v_mul_f32 v149, v5, v149
    v_lshlrev_b32 v150, 16, v131
    v_mfma_f32_16x16x32_bf16 v[204:207], a[156:159], v[96:99], v[204:207]
    v_and_b32 v151, 0xffff0000, v131
    v_mul_f32 v150, v5, v150
    s_waitcnt vmcnt(10)
    v_mfma_f32_16x16x32_bf16 v[224:227], a[144:147], v[104:107], v[224:227]
    buffer_load_dwordx4 v[56:59], v7, s[20:23], s92 offen sc1
    v_mul_f32 v151, v5, v151
    v_mfma_f32_16x16x32_bf16 v[240:243], a[144:147], v[108:111], v[240:243]
    buffer_load_dwordx4 v[60:63], v3, s[20:23], s92 offen sc1
    s_add_u32 s92, s92, 4096
    v_mfma_f32_16x16x32_bf16 v[244:247], a[148:151], v[108:111], v[244:247]
    s_waitcnt lgkmcnt(5)
    v_lshlrev_b32 v152, 16, v132
    v_mfma_f32_16x16x32_bf16 v[228:231], a[148:151], v[104:107], v[228:231]
    v_and_b32 v153, 0xffff0000, v132
    v_mul_f32 v152, v5, v152
    v_mfma_f32_16x16x32_bf16 v[232:235], a[152:155], v[104:107], v[232:235]
    v_mul_f32 v153, v5, v153
    v_lshlrev_b32 v154, 16, v133
    v_mfma_f32_16x16x32_bf16 v[248:251], a[152:155], v[108:111], v[248:251]
    v_and_b32 v155, 0xffff0000, v133
    v_mul_f32 v154, v5, v154
    v_mfma_f32_16x16x32_bf16 v[252:255], a[156:159], v[108:111], v[252:255]
    v_mul_f32 v155, v5, v155
    v_mfma_f32_16x16x32_bf16 v[236:239], a[156:159], v[104:107], v[236:239]
    s_waitcnt lgkmcnt(4)
    v_lshlrev_b32 v156, 16, v134
    s_waitcnt vmcnt(10)
    v_mfma_f32_16x16x32_bf16 v[192:195], a[160:163], v[112:115], v[192:195]
    buffer_load_dwordx4 v[64:67], v9, s[20:23], s92 offen sc1
    v_and_b32 v157, 0xffff0000, v134
    v_mfma_f32_16x16x32_bf16 v[208:211], a[160:163], v[116:119], v[208:211]
    buffer_load_dwordx4 v[68:71], v10, s[20:23], s92 offen sc1
    v_mul_f32 v156, v5, v156
    v_mfma_f32_16x16x32_bf16 v[212:215], a[164:167], v[116:119], v[212:215]
    v_mul_f32 v157, v5, v157
    v_lshlrev_b32 v158, 16, v135
    v_mfma_f32_16x16x32_bf16 v[196:199], a[164:167], v[112:115], v[196:199]
    v_and_b32 v159, 0xffff0000, v135
    v_mul_f32 v158, v5, v158
    v_mfma_f32_16x16x32_bf16 v[200:203], a[168:171], v[112:115], v[200:203]
    v_mul_f32 v159, v5, v159
    v_mfma_f32_16x16x32_bf16 v[216:219], a[168:171], v[116:119], v[216:219]
    v_mov_b32 v31, 32
    s_mov_b64 exec, 1
    v_mov_b32 v31, 0
    buffer_atomic_add v31, off, s[20:23], s89 sc0 sc1
    s_mov_b64 exec, -1
    v_mfma_f32_16x16x32_bf16 v[220:223], a[172:175], v[116:119], v[220:223]
    v_mfma_f32_16x16x32_bf16 v[204:207], a[172:175], v[112:115], v[204:207]
    s_waitcnt vmcnt(11)
    v_mfma_f32_16x16x32_bf16 v[224:227], a[160:163], v[120:123], v[224:227]
    buffer_load_dwordx4 v[72:75], v7, s[20:23], s92 offen sc1
    v_mfma_f32_16x16x32_bf16 v[240:243], a[160:163], v[124:127], v[240:243]
    buffer_load_dwordx4 v[76:79], v3, s[20:23], s92 offen sc1
    v_mfma_f32_16x16x32_bf16 v[244:247], a[164:167], v[124:127], v[244:247]
    v_mfma_f32_16x16x32_bf16 v[228:231], a[164:167], v[120:123], v[228:231]
    v_mfma_f32_16x16x32_bf16 v[232:235], a[168:171], v[120:123], v[232:235]
    v_mfma_f32_16x16x32_bf16 v[248:251], a[168:171], v[124:127], v[248:251]
    v_mfma_f32_16x16x32_bf16 v[252:255], a[172:175], v[124:127], v[252:255]
    v_mfma_f32_16x16x32_bf16 v[236:239], a[172:175], v[120:123], v[236:239]
    s_waitcnt vmcnt(11)
    v_mfma_f32_16x16x32_bf16 v[192:195], a[176:179], v[32:35], v[192:195]
    v_mfma_f32_16x16x32_bf16 v[208:211], a[176:179], v[36:39], v[208:211]
    v_mfma_f32_16x16x32_bf16 v[212:215], a[180:183], v[36:39], v[212:215]
    v_mfma_f32_16x16x32_bf16 v[196:199], a[180:183], v[32:35], v[196:199]
    v_mfma_f32_16x16x32_bf16 v[200:203], a[184:187], v[32:35], v[200:203]
    v_mfma_f32_16x16x32_bf16 v[216:219], a[184:187], v[36:39], v[216:219]
    v_mfma_f32_16x16x32_bf16 v[220:223], a[188:191], v[36:39], v[220:223]
    v_mfma_f32_16x16x32_bf16 v[204:207], a[188:191], v[32:35], v[204:207]
    s_waitcnt vmcnt(9)
    v_mfma_f32_16x16x32_bf16 v[224:227], a[176:179], v[40:43], v[224:227]
    v_mfma_f32_16x16x32_bf16 v[240:243], a[176:179], v[44:47], v[240:243]
    v_mfma_f32_16x16x32_bf16 v[244:247], a[180:183], v[44:47], v[244:247]
    v_mfma_f32_16x16x32_bf16 v[228:231], a[180:183], v[40:43], v[228:231]
    v_mfma_f32_16x16x32_bf16 v[232:235], a[184:187], v[40:43], v[232:235]
    v_mfma_f32_16x16x32_bf16 v[248:251], a[184:187], v[44:47], v[248:251]
    v_mfma_f32_16x16x32_bf16 v[252:255], a[188:191], v[44:47], v[252:255]
    v_mfma_f32_16x16x32_bf16 v[236:239], a[188:191], v[40:43], v[236:239]
    s_waitcnt vmcnt(7)
    v_mfma_f32_16x16x32_bf16 v[208:211], a[192:195], v[52:55], v[208:211]
    s_waitcnt vmcnt(2)
    v_readfirstlane_b32 s93, v31
    s_nop 0
    s_cmp_ge_u32 s93, 32
    s_cselect_b32 s93, 1, 0
    s_cselect_b32 s94, s98, 0x1000000
    v_mfma_f32_16x16x32_bf16 v[212:215], a[196:199], v[52:55], v[212:215]
    s_add_u32 m0, s96, 29184
    s_nop 0
    buffer_load_dwordx4 v14, s[20:23], s94 offen sc1 lds
    v_mfma_f32_16x16x32_bf16 v[216:219], a[200:203], v[52:55], v[216:219]
    buffer_load_dwordx4 v15, s[20:23], s94 offen offset:1024 sc1 lds
    v_mfma_f32_16x16x32_bf16 v[220:223], a[204:207], v[52:55], v[220:223]
    s_waitcnt lgkmcnt(0)
    v_mfma_f32_16x16x32_bf16 v[208:211], a[208:211], v[68:71], v[208:211]
    v_mfma_f32_16x16x32_bf16 v[212:215], a[212:215], v[68:71], v[212:215]
    v_mfma_f32_16x16x32_bf16 v[216:219], a[216:219], v[68:71], v[216:219]
    v_mfma_f32_16x16x32_bf16 v[220:223], a[220:223], v[68:71], v[220:223]
    v_mfma_f32_16x16x32_bf16 v[224:227], a[192:195], v[56:59], v[224:227]
    v_mfma_f32_16x16x32_bf16 v[228:231], a[196:199], v[56:59], v[228:231]
    v_mfma_f32_16x16x32_bf16 v[232:235], a[200:203], v[56:59], v[232:235]
    v_mfma_f32_16x16x32_bf16 v[236:239], a[204:207], v[56:59], v[236:239]
    s_waitcnt vmcnt(2)
    v_mfma_f32_16x16x32_bf16 v[224:227], a[208:211], v[72:75], v[224:227]
    v_mfma_f32_16x16x32_bf16 v[228:231], a[212:215], v[72:75], v[228:231]
    v_mfma_f32_16x16x32_bf16 v[232:235], a[216:219], v[72:75], v[232:235]
    ds_write_b128 v18, v[208:211] offset:0
    v_mfma_f32_16x16x32_bf16 v[236:239], a[220:223], v[72:75], v[236:239]
    v_mfma_f32_16x16x32_bf16 v[240:243], a[192:195], v[60:63], v[240:243]
    ds_write_b128 v18, v[212:215] offset:1024
    v_mfma_f32_16x16x32_bf16 v[244:247], a[196:199], v[60:63], v[244:247]
    v_mfma_f32_16x16x32_bf16 v[248:251], a[200:203], v[60:63], v[248:251]
    ds_write_b128 v18, v[216:219] offset:2048
    v_mfma_f32_16x16x32_bf16 v[252:255], a[204:207], v[60:63], v[252:255]
    v_mfma_f32_16x16x32_bf16 v[240:243], a[208:211], v[76:79], v[240:243]
    ds_write_b128 v18, v[220:223] offset:3072
    v_mfma_f32_16x16x32_bf16 v[244:247], a[212:215], v[76:79], v[244:247]
    v_mfma_f32_16x16x32_bf16 v[248:251], a[216:219], v[76:79], v[248:251]
    ds_write_b128 v19, v[224:227] offset:0
    v_mfma_f32_16x16x32_bf16 v[252:255], a[220:223], v[76:79], v[252:255]
    v_mfma_f32_16x16x32_bf16 v[192:195], a[192:195], v[48:51], v[192:195]
    ds_write_b128 v19, v[228:231] offset:1024
    v_mfma_f32_16x16x32_bf16 v[196:199], a[196:199], v[48:51], v[196:199]
    v_mfma_f32_16x16x32_bf16 v[200:203], a[200:203], v[48:51], v[200:203]
    ds_write_b128 v19, v[232:235] offset:2048
    v_mfma_f32_16x16x32_bf16 v[204:207], a[204:207], v[48:51], v[204:207]
    v_mfma_f32_16x16x32_bf16 v[192:195], a[208:211], v[64:67], v[192:195]
    ds_write_b128 v19, v[236:239] offset:3072
    v_mfma_f32_16x16x32_bf16 v[196:199], a[212:215], v[64:67], v[196:199]
    v_mfma_f32_16x16x32_bf16 v[200:203], a[216:219], v[64:67], v[200:203]
    ds_write_b128 v27, v[240:243] offset:0
    v_mfma_f32_16x16x32_bf16 v[204:207], a[220:223], v[64:67], v[204:207]
    ds_write_b128 v27, v[244:247] offset:1024
    ds_write_b128 v27, v[248:251] offset:2048
    ds_write_b128 v27, v[252:255] offset:3072
    s_nop 2
    s_cmp_eq_u32 s93, 1
    s_cbranch_scc1 L_zok
    v_mov_b32 v31, 32
    s_mov_b64 exec, 1
    v_mov_b32 v31, 0
    buffer_atomic_add v31, off, s[20:23], s89 sc0 sc1
    s_mov_b64 exec, -1
    s_waitcnt vmcnt(0)
    v_cmp_gt_u32 vcc, 32, v31
    s_nop 0
    s_cmp_eq_u64 vcc, 0
    s_cbranch_scc1 L_ok3
    s_mov_b32 s3, 262144
L_poll3:
    s_sleep 2
    v_mov_b32 v31, 32
    s_mov_b64 exec, 1
    v_mov_b32 v31, 0
    buffer_atomic_add v31, off, s[20:23], s89 sc0 sc1
    s_mov_b64 exec, -1
    s_waitcnt vmcnt(0)
    v_cmp_gt_u32 vcc, 32, v31
    s_nop 0
    s_cmp_eq_u64 vcc, 0
    s_cbranch_scc1 L_ok3
    s_sub_u32 s3, s3, 1
    s_cmp_lg_u32 s3, 0
    s_cbranch_scc1 L_poll3
L_ok3:
    s_add_u32 m0, s96, 29184
    s_nop 0
    buffer_load_dwordx4 v14, s[20:23], s98 offen sc1 lds
    buffer_load_dwordx4 v15, s[20:23], s98 offen offset:1024 sc1 lds
L_zok:
    s_waitcnt vmcnt(0) lgkmcnt(0)
    s_barrier
    ds_read_b128 v[32:35], v17 offset:0
    ds_read_b128 v[48:51], v17 offset:4096
    ds_read_b128 v[64:67], v17 offset:8192
    ds_read_b128 v[36:39], v17 offset:1024
    ds_read_b128 v[52:55], v17 offset:5120
    ds_read_b128 v[68:71], v17 offset:9216
    ds_read_b128 v[40:43], v17 offset:2048
    ds_read_b128 v[56:59], v17 offset:6144
    ds_read_b128 v[72:75], v17 offset:10240
    ds_read_b128 v[44:47], v17 offset:3072
    ds_read_b128 v[60:63], v17 offset:7168
    ds_read_b128 v[76:79], v17 offset:11264
    s_waitcnt lgkmcnt(10)
    v_pk_add_f32 v[192:193], v[192:193], v[32:33]
    v_pk_add_f32 v[194:195], v[194:195], v[34:35]
    v_pk_add_f32 v[192:193], v[192:193], v[48:49]
    v_pk_add_f32 v[194:195], v[194:195], v[50:51]
    s_waitcnt lgkmcnt(9)
    v_pk_add_f32 v[192:193], v[192:193], v[64:65]
    v_pk_add_f32 v[194:195], v[194:195], v[66:67]
    ds_read_b64_tr_b16 v[136:137], v0 offset:29184
    ds_read_b64_tr_b16 v[138:139], v0 offset:30208
    ds_read_b64_tr_b16 v[140:141], v0 offset:33280
    ds_read_b64_tr_b16 v[142:143], v0 offset:34304
    v_pk_mul_f32 v[192:193], v[192:193], v[4:5] op_sel_hi:[1,0]
    v_pk_mul_f32 v[194:195], v[194:195], v[4:5] op_sel_hi:[1,0]
    s_waitcnt lgkmcnt(11)
    v_pk_add_f32 v[196:197], v[196:197], v[36:37]
    v_pk_add_f32 v[198:199], v[198:199], v[38:39]
    v_pk_add_f32 v[196:197], v[196:197], v[52:53]
    v_pk_add_f32 v[198:199], v[198:199], v[54:55]
    s_waitcnt lgkmcnt(10)
    v_pk_add_f32 v[196:197], v[196:197], v[68:69]
    v_pk_add_f32 v[198:199], v[198:199], v[70:71]
    v_pk_mul_f32 v[196:197], v[196:197], v[4:5] op_sel_hi:[1,0]
    v_pk_mul_f32 v[198:199], v[198:199], v[4:5] op_sel_hi:[1,0]
    s_waitcnt lgkmcnt(8)
    v_pk_add_f32 v[200:201], v[200:201], v[40:41]
    v_pk_add_f32 v[202:203], v[202:203], v[42:43]
    v_pk_add_f32 v[200:201], v[200:201], v[56:57]
    v_pk_add_f32 v[202:203], v[202:203], v[58:59]
    s_waitcnt lgkmcnt(7)
    v_pk_add_f32 v[200:201], v[200:201], v[72:73]
    v_pk_add_f32 v[202:203], v[202:203], v[74:75]
    v_pk_mul_f32 v[200:201], v[200:201], v[4:5] op_sel_hi:[1,0]
    v_pk_mul_f32 v[202:203], v[202:203], v[4:5] op_sel_hi:[1,0]
    s_waitcnt lgkmcnt(5)
    v_pk_add_f32 v[204:205], v[204:205], v[44:45]
    v_pk_add_f32 v[206:207], v[206:207], v[46:47]
    v_pk_add_f32 v[204:205], v[204:205], v[60:61]
    v_pk_add_f32 v[206:207], v[206:207], v[62:63]
    s_waitcnt lgkmcnt(4)
    v_pk_add_f32 v[204:205], v[204:205], v[76:77]
    v_pk_add_f32 v[206:207], v[206:207], v[78:79]
    v_pk_mul_f32 v[204:205], v[204:205], v[4:5] op_sel_hi:[1,0]
    v_pk_mul_f32 v[206:207], v[206:207], v[4:5] op_sel_hi:[1,0]
    s_add_u32 s3, s99, 7168
    s_waitcnt lgkmcnt(3)
    v_lshlrev_b32 v32, 16, v136
    v_and_b32 v33, 0xffff0000, v136
    v_lshlrev_b32 v34, 16, v137
    v_and_b32 v35, 0xffff0000, v137
    v_pk_fma_f32 v[192:193], v[144:145], v[32:33], v[192:193]
    v_pk_fma_f32 v[194:195], v[146:147], v[34:35], v[194:195]
    v_cvt_pk_bf16_f32 v128, v192, v193
    v_cvt_pk_bf16_f32 v129, v194, v195
    s_waitcnt lgkmcnt(2)
    v_lshlrev_b32 v36, 16, v138
    v_and_b32 v37, 0xffff0000, v138
    v_lshlrev_b32 v38, 16, v139
    v_and_b32 v39, 0xffff0000, v139
    v_pk_fma_f32 v[196:197], v[148:149], v[36:37], v[196:197]
    v_pk_fma_f32 v[198:199], v[150:151], v[38:39], v[198:199]
    v_cvt_pk_bf16_f32 v130, v196, v197
    v_cvt_pk_bf16_f32 v131, v198, v199
    s_waitcnt lgkmcnt(1)
    v_lshlrev_b32 v40, 16, v140
    v_and_b32 v41, 0xffff0000, v140
    v_lshlrev_b32 v42, 16, v141
    v_and_b32 v43, 0xffff0000, v141
    v_pk_fma_f32 v[200:201], v[152:153], v[40:41], v[200:201]
    v_pk_fma_f32 v[202:203], v[154:155], v[42:43], v[202:203]
    v_cvt_pk_bf16_f32 v132, v200, v201
    v_cvt_pk_bf16_f32 v133, v202, v203
    s_waitcnt lgkmcnt(0)
    v_lshlrev_b32 v44, 16, v142
    v_and_b32 v45, 0xffff0000, v142
    v_lshlrev_b32 v46, 16, v143
    v_and_b32 v47, 0xffff0000, v143
    v_pk_fma_f32 v[204:205], v[156:157], v[44:45], v[204:205]
    v_pk_fma_f32 v[206:207], v[158:159], v[46:47], v[206:207]
    v_cvt_pk_bf16_f32 v134, v204, v205
    v_cvt_pk_bf16_f32 v135, v206, v207
    v_permlane16_swap_b32 v128, v130
    v_permlane16_swap_b32 v129, v131
    v_permlane16_swap_b32 v132, v134
    v_permlane16_swap_b32 v133, v135
    v_mov_b32 v136, v128
    v_mov_b32 v137, v129
    v_mov_b32 v138, v130
    v_mov_b32 v139, v131
    v_mov_b32_dpp v128, v132 row_ror:8 row_mask:0xf bank_mask:0xc
    v_mov_b32_dpp v129, v133 row_ror:8 row_mask:0xf bank_mask:0xc
    v_mov_b32_dpp v130, v134 row_ror:8 row_mask:0xf bank_mask:0xc
    v_mov_b32_dpp v131, v135 row_ror:8 row_mask:0xf bank_mask:0xc
    buffer_store_dwordx4 v[128:131], v22, s[24:27], s99 offen sc1
    v_mov_b32_dpp v132, v136 row_ror:8 row_mask:0xf bank_mask:0x3
    v_mov_b32_dpp v133, v137 row_ror:8 row_mask:0xf bank_mask:0x3
    v_mov_b32_dpp v134, v138 row_ror:8 row_mask:0xf bank_mask:0x3
    v_mov_b32_dpp v135, v139 row_ror:8 row_mask:0xf bank_mask:0x3
    buffer_store_dwordx4 v[132:135], v22, s[24:27], s3 offen sc1
L_end:
    s_endpgm
L_helper:
    s_sub_u32 s69, s2, 224
    s_and_b32 s70, s69, 7
    s_lshl_b32 s70, s70, 2
    s_lshr_b32 s74, s69, 3
    s_add_u32 s70, s70, s74
    s_lshl_b32 s75, s70, 6
    v_mov_b32 v16, 0
    v_mov_b32 v17, 0
    v_mov_b32 v18, 0
    v_mov_b32 v19, 0
    v_mov_b32 v30, 1
    v_lshlrev_b32 v15, 7, v0
    s_lshl_b32 s72, s68, 4
    s_add_u32 s72, s72, s75
    v_lshrrev_b32 v12, 2, v1
    v_add_u32 v12, s72, v12
    v_and_b32 v13, 3, v1
    v_lshlrev_b32 v13, 4, v13
    v_mul_u32_u24 v14, 896, v12
    v_add_u32 v14, v14, v13
    s_waitcnt lgkmcnt(0)
    s_mov_b32 s20, s66
    s_mov_b32 s21, s67
    s_mov_b32 s22, 16777216
    s_mov_b32 s23, 0x20000
    s_mov_b32 s36, s64
    s_mov_b32 s37, s65
    s_mov_b32 s38, 256
    s_mov_b32 s39, 0x20000
    s_cmp_lg_u32 s69, 0
    s_cbranch_scc1 L_hnz
    buffer_load_dword a249, off, s[36:39], 0 offset:128
    s_mov_b32 s3, 12648448
    buffer_store_dwordx4 v[16:19], v15, s[20:23], s3 offen sc1
    s_waitcnt vmcnt(0)
    s_barrier
    s_cmp_lg_u32 s68, 0
    s_cbranch_scc1 L_hnz
    s_mov_b64 exec, 1
    buffer_store_dword v30, off, s[36:39], 0 sc1
    s_mov_b64 exec, -1
L_hnz:
    s_mov_b32 s4, s40
    s_mov_b32 s5, s41
    s_mov_b32 s6, 1835008
    s_mov_b32 s7, 0x20000
    s_mov_b32 s24, s60
    s_mov_b32 s25, s61
    s_mov_b32 s26, 896
    s_mov_b32 s27, 0x20000
    s_getpc_b64 s[88:89]
L_pch:
    s_sub_u32 s88, s88, L_pch-gated_mix__ssm_conv_h3__swiglu_ffn__prompt_kernel
    s_subb_u32 s89, s89, 0
    s_lshr_b32 s3, s2, 3
    s_lshl_b32 s3, s3, 10
    s_lshl_b32 s91, s68, 8
    s_add_u32 s3, s3, s91
    v_and_b32 v31, 1, v1
    v_lshl_add_u32 v31, v31, 7, s3
    v_min_u32 v31, L_codeend-gated_mix__ssm_conv_h3__swiglu_ffn__prompt_kernel-4, v31
    global_load_dword a253, v31, s[88:89]
    v_lshlrev_b32 v22, 7, v0
    v_lshlrev_b32 v21, 7, v1
    s_cmp_eq_u32 s68, 1
    s_cselect_b64 s[12:13], s[56:57], s[54:55]
    s_mov_b32 s14, 1605632
    s_mov_b32 s91, 229376
    s_cmp_ge_u32 s68, 2
    s_cselect_b64 s[12:13], s[40:41], s[12:13]
    s_cselect_b32 s14, s6, s14
    s_cselect_b32 s91, 128, s91
    s_mov_b32 s15, 0x20000
    v_min_u32 v24, 55, v1
    v_mul_u32_u24 v25, 4682, v24
    v_lshrrev_b32 v25, 16, v25
    v_mul_u32_u24 v26, 14, v25
    v_sub_u32 v24, v24, v26
    s_lshr_b32 s72, s69, 1
    s_lshl_b32 s72, s72, 2
    v_add_u32 v25, s72, v25
    v_mul_u32_u24 v25, 3584, v25
    v_lshl_add_u32 v24, v24, 7, v25
    s_and_b32 s72, s69, 1
    s_mul_i32 s72, s72, 1792
    v_add_u32 v24, s72, v24
    v_add_u32 v25, s75, v1
    v_mul_u32_u24 v25, 896, v25
    s_cmp_ge_u32 s68, 2
    s_cselect_b64 vcc, -1, 0
    s_nop 1
    v_cndmask_b32 v24, v24, v25, vcc
    s_mul_i32 s72, s91, 0
    buffer_load_dword a250, v24, s[12:15], s72 offen
    s_mul_i32 s72, s91, 1
    buffer_load_dword a250, v24, s[12:15], s72 offen
    s_mul_i32 s72, s91, 2
    buffer_load_dword a250, v24, s[12:15], s72 offen
    s_mul_i32 s72, s91, 3
    buffer_load_dword a250, v24, s[12:15], s72 offen
    buffer_load_dwordx4 v[64:67], v14, s[4:7], 0 offen offset:0
    buffer_load_dwordx4 v[192:195], v13, s[24:27], 0 offen offset:0
    buffer_load_dwordx4 v[68:71], v14, s[4:7], 0 offen offset:64
    buffer_load_dwordx4 v[196:199], v13, s[24:27], 0 offen offset:64
    buffer_load_dwordx4 v[72:75], v14, s[4:7], 0 offen offset:128
    buffer_load_dwordx4 v[200:203], v13, s[24:27], 0 offen offset:128
    buffer_load_dwordx4 v[76:79], v14, s[4:7], 0 offen offset:192
    buffer_load_dwordx4 v[204:207], v13, s[24:27], 0 offen offset:192
    buffer_load_dwordx4 v[80:83], v14, s[4:7], 0 offen offset:256
    buffer_load_dwordx4 v[208:211], v13, s[24:27], 0 offen offset:256
    buffer_load_dwordx4 v[84:87], v14, s[4:7], 0 offen offset:320
    buffer_load_dwordx4 v[212:215], v13, s[24:27], 0 offen offset:320
    buffer_load_dwordx4 v[88:91], v14, s[4:7], 0 offen offset:384
    buffer_load_dwordx4 v[216:219], v13, s[24:27], 0 offen offset:384
    buffer_load_dwordx4 v[92:95], v14, s[4:7], 0 offen offset:448
    buffer_load_dwordx4 v[220:223], v13, s[24:27], 0 offen offset:448
    buffer_load_dwordx4 v[96:99], v14, s[4:7], 0 offen offset:512
    buffer_load_dwordx4 v[224:227], v13, s[24:27], 0 offen offset:512
    buffer_load_dwordx4 v[100:103], v14, s[4:7], 0 offen offset:576
    buffer_load_dwordx4 v[228:231], v13, s[24:27], 0 offen offset:576
    buffer_load_dwordx4 v[104:107], v14, s[4:7], 0 offen offset:640
    buffer_load_dwordx4 v[232:235], v13, s[24:27], 0 offen offset:640
    buffer_load_dwordx4 v[108:111], v14, s[4:7], 0 offen offset:704
    buffer_load_dwordx4 v[236:239], v13, s[24:27], 0 offen offset:704
    buffer_load_dwordx4 v[112:115], v14, s[4:7], 0 offen offset:768
    buffer_load_dwordx4 v[240:243], v13, s[24:27], 0 offen offset:768
    buffer_load_dwordx4 v[116:119], v14, s[4:7], 0 offen offset:832
    buffer_load_dwordx4 v[244:247], v13, s[24:27], 0 offen offset:832
    buffer_load_dword v31, off, s[36:39], 0 sc1
    s_mov_b32 s8, s42
    s_mov_b32 s9, s43
    s_mov_b32 s10, 1835008
    s_mov_b32 s11, 0x20000
    s_mul_i32 s72, s70, 57344
    v_min_u32 v23, 24448, v22
    buffer_load_dword a250, v22, s[8:11], s72 offen
    s_add_u32 s72, s72, 32768
    buffer_load_dword a250, v23, s[8:11], s72 offen
    s_mov_b32 s8, s44
    s_mov_b32 s9, s45
    s_mov_b32 s10, 1835008
    s_mov_b32 s11, 0x20000
    s_mul_i32 s72, s70, 57344
    v_min_u32 v23, 24448, v22
    buffer_load_dword a250, v22, s[8:11], s72 offen
    s_add_u32 s72, s72, 32768
    buffer_load_dword a250, v23, s[8:11], s72 offen
    s_waitcnt vmcnt(4)
    v_dot2_f32_bf16 v50, v64, v192, 0
    v_dot2_f32_bf16 v51, v65, v193, 0
    v_dot2_f32_bf16 v52, v66, v194, 0
    v_dot2_f32_bf16 v53, v67, v195, 0
    v_dot2_f32_bf16 v50, v68, v196, v50
    v_dot2_f32_bf16 v51, v69, v197, v51
    v_dot2_f32_bf16 v52, v70, v198, v52
    v_dot2_f32_bf16 v53, v71, v199, v53
    v_dot2_f32_bf16 v50, v72, v200, v50
    v_dot2_f32_bf16 v51, v73, v201, v51
    v_dot2_f32_bf16 v52, v74, v202, v52
    v_dot2_f32_bf16 v53, v75, v203, v53
    v_dot2_f32_bf16 v50, v76, v204, v50
    v_dot2_f32_bf16 v51, v77, v205, v51
    v_dot2_f32_bf16 v52, v78, v206, v52
    v_dot2_f32_bf16 v53, v79, v207, v53
    v_dot2_f32_bf16 v50, v80, v208, v50
    v_dot2_f32_bf16 v51, v81, v209, v51
    v_dot2_f32_bf16 v52, v82, v210, v52
    v_dot2_f32_bf16 v53, v83, v211, v53
    v_dot2_f32_bf16 v50, v84, v212, v50
    v_dot2_f32_bf16 v51, v85, v213, v51
    v_dot2_f32_bf16 v52, v86, v214, v52
    v_dot2_f32_bf16 v53, v87, v215, v53
    v_dot2_f32_bf16 v50, v88, v216, v50
    v_dot2_f32_bf16 v51, v89, v217, v51
    v_dot2_f32_bf16 v52, v90, v218, v52
    v_dot2_f32_bf16 v53, v91, v219, v53
    v_dot2_f32_bf16 v50, v92, v220, v50
    v_dot2_f32_bf16 v51, v93, v221, v51
    v_dot2_f32_bf16 v52, v94, v222, v52
    v_dot2_f32_bf16 v53, v95, v223, v53
    v_dot2_f32_bf16 v50, v96, v224, v50
    v_dot2_f32_bf16 v51, v97, v225, v51
    v_dot2_f32_bf16 v52, v98, v226, v52
    v_dot2_f32_bf16 v53, v99, v227, v53
    v_dot2_f32_bf16 v50, v100, v228, v50
    v_dot2_f32_bf16 v51, v101, v229, v51
    v_dot2_f32_bf16 v52, v102, v230, v52
    v_dot2_f32_bf16 v53, v103, v231, v53
    v_dot2_f32_bf16 v50, v104, v232, v50
    v_dot2_f32_bf16 v51, v105, v233, v51
    v_dot2_f32_bf16 v52, v106, v234, v52
    v_dot2_f32_bf16 v53, v107, v235, v53
    v_dot2_f32_bf16 v50, v108, v236, v50
    v_dot2_f32_bf16 v51, v109, v237, v51
    v_dot2_f32_bf16 v52, v110, v238, v52
    v_dot2_f32_bf16 v53, v111, v239, v53
    v_dot2_f32_bf16 v50, v112, v240, v50
    v_dot2_f32_bf16 v51, v113, v241, v51
    v_dot2_f32_bf16 v52, v114, v242, v52
    v_dot2_f32_bf16 v53, v115, v243, v53
    v_dot2_f32_bf16 v50, v116, v244, v50
    v_dot2_f32_bf16 v51, v117, v245, v51
    v_dot2_f32_bf16 v52, v118, v246, v52
    v_dot2_f32_bf16 v53, v119, v247, v53
    s_nop 2
    v_add_f32 v50, v50, v51
    v_add_f32 v52, v52, v53
    v_add_f32 v50, v50, v52
    s_nop 1
    v_add_f32_dpp v51, v50, v50 quad_perm:[1,0,3,2] row_mask:0xf bank_mask:0xf
    s_nop 1
    v_add_f32_dpp v50, v51, v51 quad_perm:[2,3,0,1] row_mask:0xf bank_mask:0xf
    v_mul_f32 v50, 0xbfb8aa3b, v50
    v_exp_f32 v50, v50
    v_lshlrev_b32 v12, 2, v12
    v_add_f32 v50, 1.0, v50
    v_rcp_f32 v50, v50
    s_mov_b32 s73, 12582912
    s_mov_b32 exec_lo, 0x11111111
    s_mov_b32 exec_hi, 0x11111111
    buffer_store_dword v50, v12, s[20:23], s73 offen sc1
    s_mov_b64 exec, -1
    v_cmp_gt_u32 vcc, 1, v31
    s_nop 0
    s_cmp_eq_u64 vcc, 0
    s_cbranch_scc1 L_ok4
    s_mov_b32 s3, 262144
L_poll4:
    s_sleep 2
    buffer_load_dword v31, off, s[36:39], 0 sc1
    s_waitcnt vmcnt(0)
    v_cmp_gt_u32 vcc, 1, v31
    s_nop 0
    s_cmp_eq_u64 vcc, 0
    s_cbranch_scc1 L_ok4
    s_sub_u32 s3, s3, 1
    s_cmp_lg_u32 s3, 0
    s_cbranch_scc1 L_poll4
L_ok4:
    s_lshl2_add_u32 s72, s70, s68
    s_lshl_b32 s72, s72, 7
    s_add_u32 s72, s72, 12648448
    s_waitcnt vmcnt(0)
    s_mov_b64 exec, 1
    buffer_atomic_add v30, off, s[20:23], s72 sc1
    s_mov_b64 exec, -1
    s_mov_b32 s8, s48
    s_mov_b32 s9, s49
    s_mov_b32 s10, 1835008
    s_mov_b32 s11, 0x20000
    s_lshl_b32 s72, s70, 13
    s_lshl_b32 s73, s68, 18
    s_add_u32 s72, s72, s73
    buffer_load_dword a250, v21, s[8:11], s72 offen
    s_add_u32 s72, s72, 1048576
    buffer_load_dword a250, v21, s[8:11], s72 offen
    s_mov_b32 s8, s58
    s_mov_b32 s9, s59
    s_mov_b32 s10, 1605632
    s_mov_b32 s11, 0x20000
    s_mul_i32 s72, s69, 50176
    v_min_u32 v23, 17280, v22
    buffer_load_dword a250, v22, s[8:11], s72 offen
    s_add_u32 s72, s72, 32768
    buffer_load_dword a250, v23, s[8:11], s72 offen
    s_endpgm
L_codeend:
.section .rodata,"a"
.p2align 6
.amdhsa_kernel gated_mix__ssm_conv_h3__swiglu_ffn__prompt_kernel
  .amdhsa_next_free_vgpr 512
  .amdhsa_next_free_sgpr 102
  .amdhsa_accum_offset 256
  .amdhsa_group_segment_fixed_size 0
  .amdhsa_kernarg_size 112
  .amdhsa_user_sgpr_count 2
  .amdhsa_user_sgpr_kernarg_segment_ptr 1
  .amdhsa_system_sgpr_workgroup_id_x 1
  .amdhsa_float_denorm_mode_32 3
.end_amdhsa_kernel
```
